```python
import torch

def _softmax(x, axis=-1):
    return torch.softmax(x, dim=axis)
def _gelu(x):
    return torch.nn.functional.gelu(x, approximate="tanh")
def _silu(x):
    return torch.nn.functional.silu(x)
def _sigmoid(x):
    return torch.sigmoid(x)
def _layernorm(x, axis=-1, eps=1e-5):
    m = x.mean(dim=axis, keepdim=True)
    v = x.var(dim=axis, keepdim=True, unbiased=False)
    return (x - m) / torch.sqrt(v + eps)
def _scatter_add(tgt, idx, src, axis=0):
    return tgt.clone().index_add_(axis, idx, src)
def _segment_sum(src, seg, n):
    out = torch.zeros((n,) + src.shape[1:], dtype=src.dtype)
    return out.index_add_(0, seg, src)
def _pad(x, pw):
    flat = tuple(v for pair in reversed(pw) for v in pair)
    return torch.nn.functional.pad(x, flat)

kernel_name = 'gated_mix__softmax_full_mha__moe_arch_mod__prompt'

def setup_inputs():

    _w = (lambda a: (lambda t: t.to(torch.bfloat16) if t.is_floating_point() else t)(torch.as_tensor(a)))
    def _A_setup():
        B, S, D = 1, 2048, 448
        return {
            "x": _w((lambda *s: torch.randn(*s, dtype=torch.bfloat16) * 0.05)(B, S, D)),
            "wqkv": _w((lambda *s: torch.randn(*s, dtype=torch.bfloat16) * 1.6)(D, 3 * D)),
            "wo": _w((lambda *s: torch.randn(*s, dtype=torch.bfloat16) * 0.1)(D, D)),
        }
    _A_in = _A_setup()

    def _B_setup():
        B, S, D, F, C = 1, 2048, 448, 1792, 8
        return {
            "x": _w((lambda *s: torch.randn(*s, dtype=torch.bfloat16) * 0.05)(B, S, D)),
            "w_r": _w((lambda *s: torch.randn(*s, dtype=torch.bfloat16) * 3.2)(D)),
            "w_gate": _w((lambda *s: torch.randn(*s, dtype=torch.bfloat16) * 0.4)(D, F)),
            "w_up": _w((lambda *s: torch.randn(*s, dtype=torch.bfloat16) * 0.4)(D, F)),
            "w_down": _w((lambda *s: torch.randn(*s, dtype=torch.bfloat16) * 0.4)(F, D)),
        }
    _B_in = _B_setup()

    return {
        "A_x": _A_in["x"],
        "A_wqkv": _A_in["wqkv"],
        "A_wo": _A_in["wo"],
        "B_x": _B_in["x"],
        "B_w_r": _B_in["w_r"],
        "B_w_gate": _B_in["w_gate"],
        "B_w_up": _B_in["w_up"],
        "B_w_down": _B_in["w_down"],
        "gate_w": _w((lambda *s: torch.randn(*s, dtype=torch.bfloat16) * 0.05)(448) * 16.0),
    }

def reference(A_x, A_wqkv, A_wo, B_x, B_w_r, B_w_gate, B_w_up, B_w_down, gate_w):
    def _A_ref(x, wqkv, wo):
        B, S, D = x.shape
        H = 16; Dh = D // H
        qkv = (lambda x, *d: x.permute(*d))((x @ wqkv).reshape(B, S, 3, H, Dh), 2, 0, 3, 1, 4)
        q, k, v = qkv[0], qkv[1], qkv[2]
        scale = Dh ** -0.5
        scores = torch.einsum("bhqd,bhkd->bhqk", q, k) * scale
        p = _softmax(scores, axis=-1)
        o = torch.einsum("bhqk,bhkd->bhqd", p, v)
        return (lambda x, *d: x.permute(*d))(o, 0, 2, 1, 3).reshape(B, S, D) @ wo

    def _B_ref(x, w_r, w_gate, w_up, w_down):
        B, S, D = x.shape
        C = 8
        r = x @ w_r
        idx = torch.argsort(-r, axis=-1)[:, :C]
        idx_e = (lambda x, n, axis: torch.repeat_interleave(x, n, dim=axis))(idx.reshape(B, C, 1), D, axis=2)
        x_sel = (lambda x, i, axis: torch.take_along_dim(x, i, dim=axis))(x, idx_e, axis=1)
        g = _silu(x_sel @ w_gate)
        u = x_sel @ w_up
        y = (g * u) @ w_down
        r_sel = _sigmoid((lambda x, i, axis: torch.take_along_dim(x, i, dim=axis))(r, idx, axis=1))
        y = y * r_sel.reshape(B, C, 1)
        b_off = (torch.arange(B) * S).reshape(B, 1)
        flat_idx = (idx + b_off).reshape(B * C)
        zero = (x * 0.0).reshape(B * S, D)
        upd = _scatter_add(zero, flat_idx, y.reshape(B * C, D), axis=0)
        return x + upd.reshape(B, S, D)

    x = A_x
    g = _sigmoid((x * gate_w).sum(-1, keepdims=True))
    a = _A_ref(x, A_wqkv, A_wo)
    b = _B_ref(x, B_w_r, B_w_gate, B_w_up, B_w_down)
    return g * a + (1 - g) * b
```

```asm
; @launch grid=(256,1,1) block=(256,1,1) lds=163840
.amdgcn_target "amdgcn-amd-amdhsa--gfx950"
.text
.globl gated_mix__softmax_full_mha__moe_arch_mod__prompt_kernel
.p2align 8
.type gated_mix__softmax_full_mha__moe_arch_mod__prompt_kernel,@function
gated_mix__softmax_full_mha__moe_arch_mod__prompt_kernel:
    s_cmp_ge_u32 s2, 256
    s_cbranch_scc1 L_end
    s_load_dwordx2 s[8:9], s[0:1], 0
    s_load_dwordx2 s[12:13], s[0:1], 8
    s_load_dwordx2 s[16:17], s[0:1], 88
    s_load_dwordx2 s[20:21], s[0:1], 16
    s_load_dwordx4 s[96:99], s[0:1], 48
    s_load_dwordx2 s[92:93], s[0:1], 72
    s_lshr_b32 s29, s2, 3
    s_getpc_b64 s[40:41]
L_pc:
    s_mul_i32 s42, s29, 1280
    v_lshl_add_u32 v3, v0, 7, s42
    v_min_u32 v3, TEXT_END - L_pc - 4, v3
    v_cmp_gt_u32 vcc, 10, v0
    s_and_saveexec_b64 s[42:43], vcc
    s_cbranch_execz L_pc2
    global_load_dword v236, v3, s[40:41]
L_pc2:
    s_mov_b64 exec, -1
    v_lshrrev_b32 v2, 6, v0
    v_and_b32 v1, 63, v0
    s_and_b32 s34, s2, 7
    s_mov_b32 s10, 1835008
    v_readfirstlane_b32 s26, v2
    s_mov_b32 s11, 0x20000
    s_mov_b32 s15, 0x20000
    s_mov_b32 s18, 10747904
    s_mov_b32 s19, 0x20000
    s_cmp_ge_u32 s29, 28
    s_cbranch_scc1 L_spare
    s_mul_i32 s36, s29, 37
    s_lshr_b32 s36, s36, 8
    s_mul_i32 s37, s36, 7
    s_sub_u32 s70, s29, s37
    s_and_b32 s24, s34, 1
    s_mul_i32 s24, s24, 7
    s_add_u32 s24, s24, s70
    s_lshr_b32 s25, s34, 1
    s_lshl_b32 s25, s25, 2
    s_add_u32 s25, s25, s36
    s_lshl_b32 s71, s34, 2
    s_add_u32 s71, s71, s36
    s_lshl_b32 s28, s36, 1
    s_add_u32 s28, s28, s70
    s_cmp_ge_u32 s28, 7
    s_cselect_b32 s37, 7, 0
    s_sub_u32 s28, s28, s37
    s_lshl_b32 s27, s25, 2
    s_add_u32 s27, s27, s26
    s_mov_b32 s14, 1204224
    s_and_b32 s44, s24, 1
    s_mul_i32 s32, s24, 192
    s_mul_i32 s36, s26, 43008
    s_add_u32 s32, s32, s36
    s_mul_i32 s33, s27, 28672
    s_lshl_b32 s35, s26, 14
    s_lshl_b32 s36, s26, 11
    s_add_u32 s36, s36, 65536
    s_lshl_b32 s45, s44, 6
    v_lshrrev_b32 v5, 3, v1
    v_mul_u32_u24 v15, 896, v5
    v_and_b32 v2, 7, v1
    v_lshrrev_b32 v3, 4, v1
    v_xor_b32 v4, v2, v3
    v_lshl_add_u32 v8, v4, 4, v15
    v_and_b32 v3, 1, v3
    v_lshlrev_b32 v3, 2, v3
    v_xor_b32 v2, v2, v3
    v_mul_u32_u24 v12, 2688, v5
    v_lshl_add_u32 v12, v2, 4, v12
    v_add_u32 v12, s45, v12
    v_add_u32 v14, 21504, v12
    v_xor_b32 v9, 64, v8
    v_add_u32 v10, 14336, v8
    v_add_u32 v9, 7168, v9
    v_add_u32 v11, 14336, v9
    s_mul_i32 s30, s28, 172032
    s_lshl_b32 s31, s28, 7
    s_add_u32 s72, s30, s32
    s_add_u32 s73, s31, s33
    s_add_u32 s28, s28, 1
    s_cmp_eq_u32 s28, 7
    s_cselect_b32 s28, 0, s28
    s_add_u32 m0, s36, 0
    s_waitcnt lgkmcnt(0)
    buffer_load_dwordx4 v12, s[12:15], s72 offen lds
    s_add_u32 m0, s36, 1024
    s_nop 0
    buffer_load_dwordx4 v14, s[12:15], s72 offen lds
    s_add_u32 m0, s35, 0
    s_nop 0
    buffer_load_dwordx4 v8, s[8:11], s73 offen lds
    s_add_u32 m0, s35, 1024
    s_nop 0
    buffer_load_dwordx4 v9, s[8:11], s73 offen lds
    s_add_u32 m0, s35, 2048
    s_nop 0
    buffer_load_dwordx4 v10, s[8:11], s73 offen lds
    s_add_u32 m0, s35, 3072
    s_nop 0
    buffer_load_dwordx4 v11, s[8:11], s73 offen lds
    s_load_dwordx2 s[68:69], s[16:17], 0
    s_mul_i32 s30, s28, 172032
    s_lshl_b32 s31, s28, 7
    s_add_u32 s74, s30, s32
    s_add_u32 s75, s31, s33
    s_add_u32 s28, s28, 1
    s_cmp_eq_u32 s28, 7
    s_cselect_b32 s28, 0, s28
    s_add_u32 m0, s36, 8192
    s_nop 0
    buffer_load_dwordx4 v12, s[12:15], s74 offen lds
    s_add_u32 m0, s36, 9216
    s_nop 0
    buffer_load_dwordx4 v14, s[12:15], s74 offen lds
    s_add_u32 m0, s35, 4096
    s_nop 0
    buffer_load_dwordx4 v8, s[8:11], s75 offen lds
    s_add_u32 m0, s35, 5120
    s_nop 0
    buffer_load_dwordx4 v9, s[8:11], s75 offen lds
    s_add_u32 m0, s35, 6144
    s_nop 0
    buffer_load_dwordx4 v10, s[8:11], s75 offen lds
    s_add_u32 m0, s35, 7168
    s_nop 0
    buffer_load_dwordx4 v11, s[8:11], s75 offen lds
    s_mul_i32 s30, s28, 172032
    s_lshl_b32 s31, s28, 7
    s_add_u32 s76, s30, s32
    s_add_u32 s77, s31, s33
    s_add_u32 s28, s28, 1
    s_cmp_eq_u32 s28, 7
    s_cselect_b32 s28, 0, s28
    s_mul_i32 s30, s28, 172032
    s_lshl_b32 s31, s28, 7
    s_add_u32 s78, s30, s32
    s_add_u32 s79, s31, s33
    s_add_u32 s28, s28, 1
    s_cmp_eq_u32 s28, 7
    s_cselect_b32 s28, 0, s28
    s_mul_i32 s30, s28, 172032
    s_lshl_b32 s31, s28, 7
    s_add_u32 s80, s30, s32
    s_add_u32 s81, s31, s33
    s_add_u32 s28, s28, 1
    s_cmp_eq_u32 s28, 7
    s_cselect_b32 s28, 0, s28
    s_mul_i32 s30, s28, 172032
    s_lshl_b32 s31, s28, 7
    s_add_u32 s82, s30, s32
    s_add_u32 s83, s31, s33
    s_add_u32 s28, s28, 1
    s_cmp_eq_u32 s28, 7
    s_cselect_b32 s28, 0, s28
    s_mul_i32 s30, s28, 172032
    s_lshl_b32 s31, s28, 7
    s_add_u32 s84, s30, s32
    s_add_u32 s85, s31, s33
    s_add_u32 s28, s28, 1
    s_cmp_eq_u32 s28, 7
    s_cselect_b32 s28, 0, s28
    v_lshl_add_u32 v226, v2, 4, v15
    v_and_b32 v7, 3, v1
    v_lshrrev_b32 v13, 2, v1
    v_mul_u32_u24 v13, 2688, v13
    v_lshl_add_u32 v13, v7, 4, v13
    s_xor_b32 s45, s44, 1
    s_lshl_b32 s45, s45, 7
    v_add_u32 v13, s45, v13
    s_lshl_b32 s45, s26, 10
    s_add_u32 s45, s45, 122880
    v_and_b32 v5, 31, v1
    v_lshrrev_b32 v6, 5, v1
    v_bfe_u32 v2, v1, 1, 3
    v_xor_b32 v2, v2, v6
    v_lshlrev_b32 v3, 7, v5
    v_add_u32 v3, s35, v3
    v_lshl_add_u32 v16, v2, 4, v3
    v_xor_b32 v17, 32, v16
    v_xor_b32 v18, 64, v16
    v_xor_b32 v19, 96, v16
    v_bfe_u32 v2, v1, 2, 2
    v_lshl_add_u32 v2, v6, 3, v2
    v_bfe_u32 v3, v1, 4, 1
    v_lshlrev_b32 v3, 5, v3
    v_lshl_add_u32 v3, v7, 3, v3
    v_lshl_add_u32 v22, v2, 6, v3
    v_add_u32 v22, 122880, v22
    v_lshl_add_u32 v20, v2, 7, v3
    v_bfe_u32 v2, v1, 3, 1
    v_lshl_add_u32 v20, v2, 6, v20
    v_add_u32 v20, 65536, v20
    v_xor_b32 v21, 64, v20
    s_cmp_gt_u32 s24, 9
    s_cbranch_scc1 P1_VVV
    s_cmp_eq_u32 s24, 9
    s_cbranch_scc1 P1_VVQ
P1_QQQ:
    s_add_u32 m0, s45, 0
    s_nop 0
    buffer_load_dwordx4 v13, s[12:15], s72 offen lds
    s_lshl_b32 s42, s27, 11
    s_add_u32 s42, s42, 1048576
    s_lshl_b32 s43, s27, 12
    s_add_u32 s43, s43, 3145728
    s_mul_i32 s38, s24, 3
    s_add_u32 s38, s38, s44
    s_lshl_b32 s3, s24, 4
    s_add_u32 s3, s3, s25
    s_lshl_b32 s3, s3, 7
    s_add_u32 s3, s3, 32768
    v_and_b32 v23, 0x13, v5
    v_bfe_u32 v2, v1, 2, 1
    v_lshl_or_b32 v23, v2, 3, v23
    v_bfe_u32 v2, v1, 3, 1
    v_lshl_or_b32 v23, v2, 2, v23
    v_lshlrev_b32 v23, 4, v23
    v_mov_b32 v98, 0x3f80
    v_mov_b32 v99, 0
    s_add_u32 s39, s38, 0
    s_add_u32 s41, s39, 2
    s_lshr_b32 s41, s41, 4
    s_sub_u32 s40, s43, s42
    s_mul_i32 s40, s40, s41
    s_add_u32 s58, s42, s40
    s_mul_i32 s40, s41, 0xf4680a
    s_add_u32 s62, s40, 0x3e8b97f6
    s_mov_b32 s63, s62
    s_add_u32 s40, s41, 17
    s_mul_i32 s41, s41, 14
    s_sub_u32 s39, s39, s41
    s_lshl_b32 s41, 1, s40
    s_add_u32 s86, s58, s41
    s_lshl_b32 s39, s39, 2
    v_add_u32 v2, s39, v6
    v_mul_u32_u24 v3, 37, v2
    v_lshrrev_b32 v3, 8, v3
    v_mul_u32_u24 v4, 7, v3
    v_sub_u32 v2, v2, v4
    v_lshrrev_b32 v4, 2, v2
    v_lshl_add_u32 v3, v3, 1, v4
    v_lshl_add_u32 v3, v3, s40, v23
    v_cmp_eq_u32 s[46:47], 3, v2
    v_and_b32 v2, 3, v2
    v_lshl_add_u32 v100, v2, 9, v3
    s_add_u32 s39, s39, 2
    v_add_u32 v2, s39, v6
    v_mul_u32_u24 v3, 37, v2
    v_lshrrev_b32 v3, 8, v3
    v_mul_u32_u24 v4, 7, v3
    v_sub_u32 v2, v2, v4
    v_lshrrev_b32 v4, 2, v2
    v_lshl_add_u32 v3, v3, 1, v4
    v_lshl_add_u32 v3, v3, s40, v23
    v_cmp_eq_u32 s[48:49], 3, v2
    v_and_b32 v2, 3, v2
    v_lshl_add_u32 v101, v2, 9, v3
    s_add_u32 s39, s38, 1
    s_add_u32 s41, s39, 2
    s_lshr_b32 s41, s41, 4
    s_sub_u32 s40, s43, s42
    s_mul_i32 s40, s40, s41
    s_add_u32 s59, s42, s40
    s_mul_i32 s40, s41, 0xf4680a
    s_add_u32 s64, s40, 0x3e8b97f6
    s_mov_b32 s65, s64
    s_add_u32 s40, s41, 17
    s_mul_i32 s41, s41, 14
    s_sub_u32 s39, s39, s41
    s_lshl_b32 s41, 1, s40
    s_add_u32 s87, s59, s41
    s_lshl_b32 s39, s39, 2
    v_add_u32 v2, s39, v6
    v_mul_u32_u24 v3, 37, v2
    v_lshrrev_b32 v3, 8, v3
    v_mul_u32_u24 v4, 7, v3
    v_sub_u32 v2, v2, v4
    v_lshrrev_b32 v4, 2, v2
    v_lshl_add_u32 v3, v3, 1, v4
    v_lshl_add_u32 v3, v3, s40, v23
    v_cmp_eq_u32 s[50:51], 3, v2
    v_and_b32 v2, 3, v2
    v_lshl_add_u32 v102, v2, 9, v3
    s_add_u32 s39, s39, 2
    v_add_u32 v2, s39, v6
    v_mul_u32_u24 v3, 37, v2
    v_lshrrev_b32 v3, 8, v3
    v_mul_u32_u24 v4, 7, v3
    v_sub_u32 v2, v2, v4
    v_lshrrev_b32 v4, 2, v2
    v_lshl_add_u32 v3, v3, 1, v4
    v_lshl_add_u32 v3, v3, s40, v23
    v_cmp_eq_u32 s[52:53], 3, v2
    v_and_b32 v2, 3, v2
    v_lshl_add_u32 v103, v2, 9, v3
    s_mul_i32 s39, s44, 3
    s_sub_u32 s39, s38, s39
    s_add_u32 s39, s39, 2
    s_add_u32 s41, s39, 2
    s_lshr_b32 s41, s41, 4
    s_sub_u32 s40, s43, s42
    s_mul_i32 s40, s40, s41
    s_add_u32 s60, s42, s40
    s_mul_i32 s40, s41, 0xf4680a
    s_add_u32 s66, s40, 0x3e8b97f6
    s_mov_b32 s67, s66
    s_add_u32 s40, s41, 17
    s_mul_i32 s41, s41, 14
    s_sub_u32 s39, s39, s41
    s_lshl_b32 s41, 1, s40
    s_add_u32 s88, s60, s41
    s_lshl_b32 s39, s39, 2
    v_add_u32 v2, s39, v6
    v_mul_u32_u24 v3, 37, v2
    v_lshrrev_b32 v3, 8, v3
    v_mul_u32_u24 v4, 7, v3
    v_sub_u32 v2, v2, v4
    v_lshrrev_b32 v4, 2, v2
    v_lshl_add_u32 v3, v3, 1, v4
    v_lshl_add_u32 v3, v3, s40, v23
    v_cmp_eq_u32 s[54:55], 3, v2
    v_and_b32 v2, 3, v2
    v_lshl_add_u32 v104, v2, 9, v3
    s_add_u32 s39, s39, 2
    v_add_u32 v2, s39, v6
    v_mul_u32_u24 v3, 37, v2
    v_lshrrev_b32 v3, 8, v3
    v_mul_u32_u24 v4, 7, v3
    v_sub_u32 v2, v2, v4
    v_lshrrev_b32 v4, 2, v2
    v_lshl_add_u32 v3, v3, 1, v4
    v_lshl_add_u32 v3, v3, s40, v23
    v_cmp_eq_u32 s[56:57], 3, v2
    v_and_b32 v2, 3, v2
    v_lshl_add_u32 v105, v2, 9, v3
    s_lshr_b32 s100, s2, 4
    s_lshl_b32 s100, s100, 2
    s_add_u32 s100, s100, s26
    s_lshl_b32 s100, s100, 3
    s_and_b32 s101, s2, 7
    s_add_u32 s100, s100, s101
    s_lshl_b32 s100, s100, 1
    s_and_b32 s101, s29, 1
    s_add_u32 s100, s100, s101
    s_lshl_b32 s101, s100, 11
    s_add_u32 s101, s101, 7340032
    v_lshrrev_b32 v2, 3, v0
    v_min_u32 v2, 1, v2
    v_lshlrev_b32 v3, 4, v1
    v_lshl_or_b32 v85, v2, 30, v3
    v_mov_b32 v80, -1
    v_mov_b32 v81, -1
    v_mov_b32 v82, -1
    v_mov_b32 v83, -1
    s_waitcnt lgkmcnt(0)
    s_mul_i32 s68, s68, 1664525
    s_add_u32 s68, s68, 1013904223
    s_mul_i32 s69, s69, 22695477
    s_add_u32 s69, s69, 1
    s_waitcnt vmcnt(7)
    s_barrier
    ds_read_b128 a[0:3], v16 offset:0
    ds_read_b64_tr_b16 v[24:25], v20 offset:0
    ds_read_b64_tr_b16 v[26:27], v20 offset:512
    ds_read_b64_tr_b16 v[28:29], v21 offset:0
    ds_read_b64_tr_b16 v[30:31], v21 offset:512
    ds_read_b128 a[4:7], v17 offset:0
    ds_read_b64_tr_b16 v[32:33], v20 offset:2048
    ds_read_b64_tr_b16 v[34:35], v20 offset:2560
    ds_read_b64_tr_b16 v[36:37], v21 offset:2048
    ds_read_b64_tr_b16 v[38:39], v21 offset:2560
    s_add_u32 m0, s36, 16384
    s_waitcnt lgkmcnt(7)
    v_mfma_f32_32x32x16_bf16 v[112:127], v[24:27], a[0:3], 0
    buffer_load_dwordx4 v12, s[12:15], s76 offen lds
    ds_read_b128 a[8:11], v18 offset:0
    ds_read_b64_tr_b16 v[40:41], v20 offset:4096
    ds_read_b64_tr_b16 v[42:43], v20 offset:4608
    s_add_u32 m0, s36, 17408
    s_waitcnt lgkmcnt(8)
    v_mfma_f32_32x32x16_bf16 v[128:143], v[28:31], a[0:3], 0
    buffer_load_dwordx4 v14, s[12:15], s76 offen lds
    ds_read_b64_tr_b16 v[44:45], v21 offset:4096
    ds_read_b64_tr_b16 v[46:47], v21 offset:4608
    s_add_u32 m0, s35, 8192
    s_waitcnt lgkmcnt(7)
    v_mfma_f32_32x32x16_bf16 v[112:127], v[32:35], a[4:7], v[112:127]
    buffer_load_dwordx4 v8, s[8:11], s77 offen lds
    ds_read_b128 a[12:15], v19 offset:0
    ds_read_b64_tr_b16 v[24:25], v20 offset:6144
    ds_read_b64_tr_b16 v[26:27], v20 offset:6656
    s_add_u32 m0, s35, 9216
    s_waitcnt lgkmcnt(8)
    v_mfma_f32_32x32x16_bf16 v[128:143], v[36:39], a[4:7], v[128:143]
    buffer_load_dwordx4 v9, s[8:11], s77 offen lds
    ds_read_b64_tr_b16 v[28:29], v21 offset:6144
    ds_read_b64_tr_b16 v[30:31], v21 offset:6656
    s_add_u32 m0, s35, 10240
    s_waitcnt lgkmcnt(7)
    v_mfma_f32_32x32x16_bf16 v[112:127], v[40:43], a[8:11], v[112:127]
    buffer_load_dwordx4 v10, s[8:11], s77 offen lds
    s_waitcnt vmcnt(6)
    s_barrier
    ds_read_b128 a[16:19], v16 offset:4096
    ds_read_b64_tr_b16 v[32:33], v20 offset:8192
    ds_read_b64_tr_b16 v[34:35], v20 offset:8704
    s_add_u32 m0, s35, 11264
    s_waitcnt lgkmcnt(8)
    v_mfma_f32_32x32x16_bf16 v[128:143], v[44:47], a[8:11], v[128:143]
    buffer_load_dwordx4 v11, s[8:11], s77 offen lds
    ds_read_b64_tr_b16 v[36:37], v21 offset:8192
    ds_read_b64_tr_b16 v[38:39], v21 offset:8704
    s_add_u32 m0, s36, 24576
    s_waitcnt lgkmcnt(7)
    v_mfma_f32_32x32x16_bf16 v[112:127], v[24:27], a[12:15], v[112:127]
    buffer_load_dwordx4 v12, s[12:15], s78 offen lds
    ds_read_b128 a[20:23], v17 offset:4096
    ds_read_b64_tr_b16 v[40:41], v20 offset:10240
    ds_read_b64_tr_b16 v[42:43], v20 offset:10752
    s_add_u32 m0, s36, 25600
    s_waitcnt lgkmcnt(8)
    v_mfma_f32_32x32x16_bf16 v[128:143], v[28:31], a[12:15], v[128:143]
    buffer_load_dwordx4 v14, s[12:15], s78 offen lds
    ds_read_b64_tr_b16 v[44:45], v21 offset:10240
    ds_read_b64_tr_b16 v[46:47], v21 offset:10752
    s_add_u32 m0, s35, 12288
    s_waitcnt lgkmcnt(7)
    v_mfma_f32_32x32x16_bf16 v[112:127], v[32:35], a[16:19], v[112:127]
    buffer_load_dwordx4 v8, s[8:11], s79 offen lds
    ds_read_b128 a[24:27], v18 offset:4096
    ds_read_b64_tr_b16 v[24:25], v20 offset:12288
    ds_read_b64_tr_b16 v[26:27], v20 offset:12800
    s_add_u32 m0, s35, 13312
    s_waitcnt lgkmcnt(8)
    v_mfma_f32_32x32x16_bf16 v[128:143], v[36:39], a[16:19], v[128:143]
    buffer_load_dwordx4 v9, s[8:11], s79 offen lds
    ds_read_b64_tr_b16 v[28:29], v21 offset:12288
    ds_read_b64_tr_b16 v[30:31], v21 offset:12800
    s_add_u32 m0, s35, 14336
    s_waitcnt lgkmcnt(7)
    v_mfma_f32_32x32x16_bf16 v[112:127], v[40:43], a[20:23], v[112:127]
    buffer_load_dwordx4 v10, s[8:11], s79 offen lds
    ds_read_b128 a[28:31], v19 offset:4096
    ds_read_b64_tr_b16 v[32:33], v20 offset:14336
    ds_read_b64_tr_b16 v[34:35], v20 offset:14848
    s_add_u32 m0, s35, 15360
    s_waitcnt lgkmcnt(8)
    v_mfma_f32_32x32x16_bf16 v[128:143], v[44:47], a[20:23], v[128:143]
    buffer_load_dwordx4 v11, s[8:11], s79 offen lds
    ds_read_b64_tr_b16 v[36:37], v21 offset:14336
    ds_read_b64_tr_b16 v[38:39], v21 offset:14848
    s_add_u32 m0, s36, 32768
    s_waitcnt lgkmcnt(7)
    v_mfma_f32_32x32x16_bf16 v[112:127], v[24:27], a[24:27], v[112:127]
    buffer_load_dwordx4 v12, s[12:15], s80 offen lds
    s_waitcnt vmcnt(7)
    s_barrier
    ds_read_b128 a[32:35], v16 offset:8192
    ds_read_b64_tr_b16 v[40:41], v20 offset:16384
    ds_read_b64_tr_b16 v[42:43], v20 offset:16896
    s_add_u32 m0, s36, 33792
    s_waitcnt lgkmcnt(8)
    v_mfma_f32_32x32x16_bf16 v[128:143], v[28:31], a[24:27], v[128:143]
    buffer_load_dwordx4 v14, s[12:15], s80 offen lds
    ds_read_b64_tr_b16 v[44:45], v21 offset:16384
    ds_read_b64_tr_b16 v[46:47], v21 offset:16896
    s_add_u32 m0, s35, 0
    s_waitcnt lgkmcnt(7)
    v_mfma_f32_32x32x16_bf16 v[112:127], v[32:35], a[28:31], v[112:127]
    buffer_load_dwordx4 v8, s[8:11], s81 offen lds
    ds_read_b128 a[36:39], v17 offset:8192
    ds_read_b64_tr_b16 v[24:25], v20 offset:18432
    ds_read_b64_tr_b16 v[26:27], v20 offset:18944
    s_add_u32 m0, s35, 1024
    s_waitcnt lgkmcnt(8)
    v_mfma_f32_32x32x16_bf16 v[128:143], v[36:39], a[28:31], v[128:143]
    buffer_load_dwordx4 v9, s[8:11], s81 offen lds
    ds_read_b64_tr_b16 v[28:29], v21 offset:18432
    ds_read_b64_tr_b16 v[30:31], v21 offset:18944
    s_add_u32 m0, s35, 2048
    s_waitcnt lgkmcnt(7)
    v_mfma_f32_32x32x16_bf16 v[112:127], v[40:43], a[32:35], v[112:127]
    buffer_load_dwordx4 v10, s[8:11], s81 offen lds
    ds_read_b128 a[40:43], v18 offset:8192
    ds_read_b64_tr_b16 v[32:33], v20 offset:20480
    ds_read_b64_tr_b16 v[34:35], v20 offset:20992
    s_add_u32 m0, s35, 3072
    s_waitcnt lgkmcnt(8)
    v_mfma_f32_32x32x16_bf16 v[128:143], v[44:47], a[32:35], v[128:143]
    buffer_load_dwordx4 v11, s[8:11], s81 offen lds
    ds_read_b64_tr_b16 v[36:37], v21 offset:20480
    ds_read_b64_tr_b16 v[38:39], v21 offset:20992
    s_add_u32 m0, s36, 40960
    s_waitcnt lgkmcnt(7)
    v_mfma_f32_32x32x16_bf16 v[112:127], v[24:27], a[36:39], v[112:127]
    buffer_load_dwordx4 v12, s[12:15], s82 offen lds
    ds_read_b128 a[44:47], v19 offset:8192
    ds_read_b64_tr_b16 v[40:41], v20 offset:22528
    ds_read_b64_tr_b16 v[42:43], v20 offset:23040
    s_add_u32 m0, s36, 41984
    s_waitcnt lgkmcnt(8)
    v_mfma_f32_32x32x16_bf16 v[128:143], v[28:31], a[36:39], v[128:143]
    buffer_load_dwordx4 v14, s[12:15], s82 offen lds
    ds_read_b64_tr_b16 v[44:45], v21 offset:22528
    ds_read_b64_tr_b16 v[46:47], v21 offset:23040
    s_add_u32 m0, s35, 4096
    s_waitcnt lgkmcnt(7)
    v_mfma_f32_32x32x16_bf16 v[112:127], v[32:35], a[40:43], v[112:127]
    buffer_load_dwordx4 v8, s[8:11], s83 offen lds
    s_waitcnt vmcnt(9)
    s_barrier
    ds_read_b128 a[48:51], v16 offset:12288
    ds_read_b64_tr_b16 v[24:25], v20 offset:24576
    ds_read_b64_tr_b16 v[26:27], v20 offset:25088
    s_add_u32 m0, s35, 5120
    s_waitcnt lgkmcnt(8)
    v_mfma_f32_32x32x16_bf16 v[128:143], v[36:39], a[40:43], v[128:143]
    buffer_load_dwordx4 v9, s[8:11], s83 offen lds
    ds_read_b64_tr_b16 v[28:29], v21 offset:24576
    ds_read_b64_tr_b16 v[30:31], v21 offset:25088
    s_add_u32 m0, s35, 6144
    s_waitcnt lgkmcnt(7)
    v_mfma_f32_32x32x16_bf16 v[112:127], v[40:43], a[44:47], v[112:127]
    buffer_load_dwordx4 v10, s[8:11], s83 offen lds
    ds_read_b128 a[52:55], v17 offset:12288
    ds_read_b64_tr_b16 v[32:33], v20 offset:26624
    ds_read_b64_tr_b16 v[34:35], v20 offset:27136
    s_add_u32 m0, s35, 7168
    s_waitcnt lgkmcnt(8)
    v_mfma_f32_32x32x16_bf16 v[128:143], v[44:47], a[44:47], v[128:143]
    buffer_load_dwordx4 v11, s[8:11], s83 offen lds
    ds_read_b64_tr_b16 v[36:37], v21 offset:26624
    ds_read_b64_tr_b16 v[38:39], v21 offset:27136
    s_add_u32 m0, s36, 49152
    s_waitcnt lgkmcnt(7)
    v_mfma_f32_32x32x16_bf16 v[112:127], v[24:27], a[48:51], v[112:127]
    buffer_load_dwordx4 v12, s[12:15], s84 offen lds
    ds_read_b128 a[56:59], v18 offset:12288
    ds_read_b64_tr_b16 v[40:41], v20 offset:28672
    ds_read_b64_tr_b16 v[42:43], v20 offset:29184
    s_add_u32 m0, s36, 50176
    s_waitcnt lgkmcnt(8)
    v_mfma_f32_32x32x16_bf16 v[128:143], v[28:31], a[48:51], v[128:143]
    buffer_load_dwordx4 v14, s[12:15], s84 offen lds
    ds_read_b64_tr_b16 v[44:45], v21 offset:28672
    ds_read_b64_tr_b16 v[46:47], v21 offset:29184
    s_add_u32 m0, s35, 8192
    s_waitcnt lgkmcnt(7)
    v_mfma_f32_32x32x16_bf16 v[112:127], v[32:35], a[52:55], v[112:127]
    buffer_load_dwordx4 v8, s[8:11], s85 offen lds
    ds_read_b128 a[60:63], v19 offset:12288
    ds_read_b64_tr_b16 v[24:25], v20 offset:30720
    ds_read_b64_tr_b16 v[26:27], v20 offset:31232
    s_add_u32 m0, s35, 9216
    s_waitcnt lgkmcnt(8)
    v_mfma_f32_32x32x16_bf16 v[128:143], v[36:39], a[52:55], v[128:143]
    buffer_load_dwordx4 v9, s[8:11], s85 offen lds
    ds_read_b64_tr_b16 v[28:29], v21 offset:30720
    ds_read_b64_tr_b16 v[30:31], v21 offset:31232
    s_add_u32 m0, s35, 10240
    s_waitcnt lgkmcnt(7)
    v_mfma_f32_32x32x16_bf16 v[112:127], v[40:43], a[56:59], v[112:127]
    buffer_load_dwordx4 v10, s[8:11], s85 offen lds
    s_waitcnt vmcnt(11)
    s_barrier
    ds_read_b128 a[64:67], v16 offset:0
    ds_read_b64_tr_b16 v[32:33], v20 offset:32768
    ds_read_b64_tr_b16 v[34:35], v20 offset:33280
    s_add_u32 m0, s35, 11264
    s_waitcnt lgkmcnt(8)
    v_mfma_f32_32x32x16_bf16 v[128:143], v[44:47], a[56:59], v[128:143]
    buffer_load_dwordx4 v11, s[8:11], s85 offen lds
    ds_read_b64_tr_b16 v[36:37], v21 offset:32768
    ds_read_b64_tr_b16 v[38:39], v21 offset:33280
    s_add_u32 m0, s45, 4096
    s_waitcnt lgkmcnt(7)
    v_mfma_f32_32x32x16_bf16 v[112:127], v[24:27], a[60:63], v[112:127]
    buffer_load_dwordx4 v13, s[12:15], s74 offen lds
    ds_read_b128 a[68:71], v17 offset:0
    ds_read_b64_tr_b16 v[40:41], v20 offset:34816
    ds_read_b64_tr_b16 v[42:43], v20 offset:35328
    s_add_u32 m0, s45, 8192
    s_waitcnt lgkmcnt(8)
    v_mfma_f32_32x32x16_bf16 v[128:143], v[28:31], a[60:63], v[128:143]
    buffer_load_dwordx4 v13, s[12:15], s76 offen lds
    ds_read_b64_tr_b16 v[44:45], v21 offset:34816
    ds_read_b64_tr_b16 v[46:47], v21 offset:35328
    s_add_u32 m0, s45, 12288
    s_waitcnt lgkmcnt(7)
    v_mfma_f32_32x32x16_bf16 v[112:127], v[32:35], a[64:67], v[112:127]
    buffer_load_dwordx4 v13, s[12:15], s78 offen lds
    ds_read_b128 a[72:75], v18 offset:0
    ds_read_b64_tr_b16 v[24:25], v20 offset:36864
    ds_read_b64_tr_b16 v[26:27], v20 offset:37376
    s_add_u32 m0, s45, 16384
    s_waitcnt lgkmcnt(8)
    v_mfma_f32_32x32x16_bf16 v[128:143], v[36:39], a[64:67], v[128:143]
    buffer_load_dwordx4 v13, s[12:15], s80 offen lds
    ds_read_b64_tr_b16 v[28:29], v21 offset:36864
    ds_read_b64_tr_b16 v[30:31], v21 offset:37376
    s_add_u32 m0, s45, 20480
    s_waitcnt lgkmcnt(7)
    v_mfma_f32_32x32x16_bf16 v[112:127], v[40:43], a[68:71], v[112:127]
    buffer_load_dwordx4 v13, s[12:15], s82 offen lds
    ds_read_b128 a[76:79], v19 offset:0
    ds_read_b64_tr_b16 v[32:33], v20 offset:38912
    ds_read_b64_tr_b16 v[34:35], v20 offset:39424
    s_add_u32 m0, s45, 24576
    s_waitcnt lgkmcnt(8)
    v_mfma_f32_32x32x16_bf16 v[128:143], v[44:47], a[68:71], v[128:143]
    buffer_load_dwordx4 v13, s[12:15], s84 offen lds
    ds_read_b64_tr_b16 v[36:37], v21 offset:38912
    ds_read_b64_tr_b16 v[38:39], v21 offset:39424
    s_waitcnt lgkmcnt(7)
    v_mfma_f32_32x32x16_bf16 v[112:127], v[24:27], a[72:75], v[112:127]
    s_waitcnt vmcnt(12)
    s_barrier
    ds_read_b128 a[80:83], v16 offset:4096
    ds_read_b64_tr_b16 v[40:41], v20 offset:40960
    ds_read_b64_tr_b16 v[42:43], v20 offset:41472
    buffer_store_dwordx4 v[80:83], v85, s[16:19], s3 offen sc1
    s_waitcnt lgkmcnt(8)
    v_mfma_f32_32x32x16_bf16 v[128:143], v[28:31], a[72:75], v[128:143]
    ds_read_b64_tr_b16 v[44:45], v21 offset:40960
    ds_read_b64_tr_b16 v[46:47], v21 offset:41472
    s_waitcnt lgkmcnt(7)
    v_mfma_f32_32x32x16_bf16 v[112:127], v[32:35], a[76:79], v[112:127]
    ds_read_b128 a[84:87], v17 offset:4096
    ds_read_b64_tr_b16 v[24:25], v20 offset:43008
    ds_read_b64_tr_b16 v[26:27], v20 offset:43520
    s_waitcnt lgkmcnt(8)
    v_mfma_f32_32x32x16_bf16 v[128:143], v[36:39], a[76:79], v[128:143]
    ds_read_b64_tr_b16 v[28:29], v21 offset:43008
    ds_read_b64_tr_b16 v[30:31], v21 offset:43520
    s_waitcnt lgkmcnt(7)
    v_mfma_f32_32x32x16_bf16 v[112:127], v[40:43], a[80:83], v[112:127]
    ds_read_b128 a[88:91], v18 offset:4096
    ds_read_b64_tr_b16 v[32:33], v20 offset:45056
    ds_read_b64_tr_b16 v[34:35], v20 offset:45568
    s_waitcnt lgkmcnt(8)
    v_mfma_f32_32x32x16_bf16 v[128:143], v[44:47], a[80:83], v[128:143]
    ds_read_b64_tr_b16 v[36:37], v21 offset:45056
    ds_read_b64_tr_b16 v[38:39], v21 offset:45568
    s_waitcnt lgkmcnt(7)
    v_mfma_f32_32x32x16_bf16 v[112:127], v[24:27], a[84:87], v[112:127]
    ds_read_b128 a[92:95], v19 offset:4096
    ds_read_b64_tr_b16 v[40:41], v20 offset:47104
    ds_read_b64_tr_b16 v[42:43], v20 offset:47616
    s_waitcnt lgkmcnt(8)
    v_mfma_f32_32x32x16_bf16 v[128:143], v[28:31], a[84:87], v[128:143]
    ds_read_b64_tr_b16 v[44:45], v21 offset:47104
    ds_read_b64_tr_b16 v[46:47], v21 offset:47616
    s_waitcnt lgkmcnt(7)
    v_mfma_f32_32x32x16_bf16 v[112:127], v[32:35], a[88:91], v[112:127]
    s_waitcnt vmcnt(7)
    s_barrier
    ds_read_b128 a[96:99], v16 offset:8192
    ds_read_b64_tr_b16 v[24:25], v20 offset:49152
    ds_read_b64_tr_b16 v[26:27], v20 offset:49664
    s_waitcnt lgkmcnt(8)
    v_mfma_f32_32x32x16_bf16 v[128:143], v[36:39], a[88:91], v[128:143]
    ds_read_b64_tr_b16 v[28:29], v21 offset:49152
    ds_read_b64_tr_b16 v[30:31], v21 offset:49664
    s_waitcnt lgkmcnt(7)
    v_mfma_f32_32x32x16_bf16 v[112:127], v[40:43], a[92:95], v[112:127]
    ds_read_b128 a[100:103], v17 offset:8192
    ds_read_b64_tr_b16 v[32:33], v20 offset:51200
    ds_read_b64_tr_b16 v[34:35], v20 offset:51712
    s_waitcnt lgkmcnt(8)
    v_mfma_f32_32x32x16_bf16 v[128:143], v[44:47], a[92:95], v[128:143]
    ds_read_b64_tr_b16 v[36:37], v21 offset:51200
    ds_read_b64_tr_b16 v[38:39], v21 offset:51712
    s_waitcnt lgkmcnt(7)
    v_mfma_f32_32x32x16_bf16 v[112:127], v[24:27], a[96:99], v[112:127]
    ds_read_b128 a[104:107], v18 offset:8192
    ds_read_b64_tr_b16 v[40:41], v20 offset:53248
    ds_read_b64_tr_b16 v[42:43], v20 offset:53760
    s_waitcnt lgkmcnt(8)
    v_mfma_f32_32x32x16_bf16 v[128:143], v[28:31], a[96:99], v[128:143]
    ds_read_b64_tr_b16 v[44:45], v21 offset:53248
    ds_read_b64_tr_b16 v[46:47], v21 offset:53760
    s_waitcnt lgkmcnt(7)
    v_mfma_f32_32x32x16_bf16 v[112:127], v[32:35], a[100:103], v[112:127]
    ds_read_b128 a[108:111], v19 offset:8192
    ds_read_b64_tr_b16 v[24:25], v20 offset:55296
    ds_read_b64_tr_b16 v[26:27], v20 offset:55808
    s_waitcnt lgkmcnt(8)
    v_mfma_f32_32x32x16_bf16 v[128:143], v[36:39], a[100:103], v[128:143]
    ds_read_b64_tr_b16 v[28:29], v21 offset:55296
    ds_read_b64_tr_b16 v[30:31], v21 offset:55808
    s_waitcnt lgkmcnt(7)
    v_mfma_f32_32x32x16_bf16 v[112:127], v[40:43], a[104:107], v[112:127]
    s_waitcnt lgkmcnt(5)
    v_mfma_f32_32x32x16_bf16 v[128:143], v[44:47], a[104:107], v[128:143]
    s_waitcnt lgkmcnt(2)
    v_mfma_f32_32x32x16_bf16 v[112:127], v[24:27], a[108:111], v[112:127]
    s_waitcnt lgkmcnt(0)
    v_mfma_f32_32x32x16_bf16 v[128:143], v[28:31], a[108:111], v[128:143]
    s_waitcnt vmcnt(5)
    s_barrier
    ds_read_b64_tr_b16 v[24:25], v22 offset:0
    ds_read_b64_tr_b16 v[26:27], v22 offset:256
    ds_read_b64_tr_b16 v[28:29], v22 offset:1024
    ds_read_b64_tr_b16 v[30:31], v22 offset:1280
    ds_read_b64_tr_b16 v[32:33], v22 offset:2048
    ds_read_b64_tr_b16 v[34:35], v22 offset:2304
    ds_read_b64_tr_b16 v[36:37], v22 offset:3072
    ds_read_b64_tr_b16 v[38:39], v22 offset:3328
    ds_read_b64_tr_b16 v[40:41], v22 offset:4096
    ds_read_b64_tr_b16 v[42:43], v22 offset:4352
    s_waitcnt lgkmcnt(8)
    v_mfma_f32_32x32x16_bf16 v[144:159], v[24:27], a[0:3], 0
    ds_read_b64_tr_b16 v[44:45], v22 offset:5120
    ds_read_b64_tr_b16 v[46:47], v22 offset:5376
    v_pk_mul_f32 v[112:113], v[112:113], s[62:63]
    v_pk_mul_f32 v[114:115], v[114:115], s[62:63]
    v_pk_mul_f32 v[116:117], v[116:117], s[62:63]
    s_waitcnt lgkmcnt(8)
    v_mfma_f32_32x32x16_bf16 v[144:159], v[28:31], a[4:7], v[144:159]
    ds_read_b64_tr_b16 v[24:25], v22 offset:6144
    ds_read_b64_tr_b16 v[26:27], v22 offset:6400
    v_pk_mul_f32 v[118:119], v[118:119], s[62:63]
    v_cvt_pk_bf16_f32 v56, v112, v113
    v_cvt_pk_bf16_f32 v58, v116, v117
    s_waitcnt lgkmcnt(8)
    v_mfma_f32_32x32x16_bf16 v[144:159], v[32:35], a[8:11], v[144:159]
    ds_read_b64_tr_b16 v[28:29], v22 offset:7168
    ds_read_b64_tr_b16 v[30:31], v22 offset:7424
    v_cvt_pk_bf16_f32 v57, v114, v115
    v_cvt_pk_bf16_f32 v59, v118, v119
    v_permlane32_swap_b32 v56, v58
    s_cmp_lg_u64 s[46:47], 0
    v_permlane32_swap_b32 v57, v59
    s_cbranch_scc1 P1_QQQ_x00
P1_QQQ_e00:
    buffer_store_dwordx4 v[56:59], v100, s[16:19], s58 offen sc1
    s_waitcnt lgkmcnt(8)
    v_mfma_f32_32x32x16_bf16 v[144:159], v[36:39], a[12:15], v[144:159]
    ds_read_b64_tr_b16 v[32:33], v22 offset:8192
    ds_read_b64_tr_b16 v[34:35], v22 offset:8448
    v_pk_mul_f32 v[120:121], v[120:121], s[62:63]
    v_pk_mul_f32 v[122:123], v[122:123], s[62:63]
    v_pk_mul_f32 v[124:125], v[124:125], s[62:63]
    s_waitcnt lgkmcnt(8)
    v_mfma_f32_32x32x16_bf16 v[144:159], v[40:43], a[16:19], v[144:159]
    ds_read_b64_tr_b16 v[36:37], v22 offset:9216
    ds_read_b64_tr_b16 v[38:39], v22 offset:9472
    v_pk_mul_f32 v[126:127], v[126:127], s[62:63]
    v_cvt_pk_bf16_f32 v60, v120, v121
    v_cvt_pk_bf16_f32 v62, v124, v125
    s_waitcnt lgkmcnt(8)
    v_mfma_f32_32x32x16_bf16 v[144:159], v[44:47], a[20:23], v[144:159]
    ds_read_b64_tr_b16 v[40:41], v22 offset:10240
    ds_read_b64_tr_b16 v[42:43], v22 offset:10496
    v_cvt_pk_bf16_f32 v61, v122, v123
    v_cvt_pk_bf16_f32 v63, v126, v127
    v_permlane32_swap_b32 v60, v62
    s_cmp_lg_u64 s[48:49], 0
    v_permlane32_swap_b32 v61, v63
    s_cbranch_scc1 P1_QQQ_x01
P1_QQQ_e01:
    buffer_store_dwordx4 v[60:63], v101, s[16:19], s58 offen sc1
    s_waitcnt lgkmcnt(8)
    v_mfma_f32_32x32x16_bf16 v[144:159], v[24:27], a[24:27], v[144:159]
    ds_read_b64_tr_b16 v[44:45], v22 offset:11264
    ds_read_b64_tr_b16 v[46:47], v22 offset:11520
    v_pk_mul_f32 v[128:129], v[128:129], s[64:65]
    v_pk_mul_f32 v[130:131], v[130:131], s[64:65]
    v_pk_mul_f32 v[132:133], v[132:133], s[64:65]
    s_waitcnt lgkmcnt(8)
    v_mfma_f32_32x32x16_bf16 v[144:159], v[28:31], a[28:31], v[144:159]
    s_waitcnt vmcnt(4)
    s_barrier
    ds_read_b64_tr_b16 v[24:25], v22 offset:12288
    ds_read_b64_tr_b16 v[26:27], v22 offset:12544
    v_pk_mul_f32 v[134:135], v[134:135], s[64:65]
    v_cvt_pk_bf16_f32 v64, v128, v129
    v_cvt_pk_bf16_f32 v66, v132, v133
    s_waitcnt lgkmcnt(8)
    v_mfma_f32_32x32x16_bf16 v[144:159], v[32:35], a[32:35], v[144:159]
    ds_read_b64_tr_b16 v[28:29], v22 offset:13312
    ds_read_b64_tr_b16 v[30:31], v22 offset:13568
    v_cvt_pk_bf16_f32 v65, v130, v131
    v_cvt_pk_bf16_f32 v67, v134, v135
    v_permlane32_swap_b32 v64, v66
    s_cmp_lg_u64 s[50:51], 0
    v_permlane32_swap_b32 v65, v67
    s_cbranch_scc1 P1_QQQ_x10
P1_QQQ_e10:
    buffer_store_dwordx4 v[64:67], v102, s[16:19], s59 offen sc1
    s_waitcnt lgkmcnt(8)
    v_mfma_f32_32x32x16_bf16 v[144:159], v[36:39], a[36:39], v[144:159]
    ds_read_b64_tr_b16 v[32:33], v22 offset:14336
    ds_read_b64_tr_b16 v[34:35], v22 offset:14592
    v_pk_mul_f32 v[136:137], v[136:137], s[64:65]
    v_pk_mul_f32 v[138:139], v[138:139], s[64:65]
    v_pk_mul_f32 v[140:141], v[140:141], s[64:65]
    s_waitcnt lgkmcnt(8)
    v_mfma_f32_32x32x16_bf16 v[144:159], v[40:43], a[40:43], v[144:159]
    ds_read_b64_tr_b16 v[36:37], v22 offset:15360
    ds_read_b64_tr_b16 v[38:39], v22 offset:15616
    v_pk_mul_f32 v[142:143], v[142:143], s[64:65]
    v_cvt_pk_bf16_f32 v68, v136, v137
    v_cvt_pk_bf16_f32 v70, v140, v141
    s_waitcnt lgkmcnt(8)
    v_mfma_f32_32x32x16_bf16 v[144:159], v[44:47], a[44:47], v[144:159]
    ds_read_b64_tr_b16 v[40:41], v22 offset:16384
    ds_read_b64_tr_b16 v[42:43], v22 offset:16640
    v_cvt_pk_bf16_f32 v69, v138, v139
    v_cvt_pk_bf16_f32 v71, v142, v143
    v_permlane32_swap_b32 v68, v70
    s_cmp_lg_u64 s[52:53], 0
    v_permlane32_swap_b32 v69, v71
    s_cbranch_scc1 P1_QQQ_x11
P1_QQQ_e11:
    buffer_store_dwordx4 v[68:71], v103, s[16:19], s59 offen sc1
    s_waitcnt lgkmcnt(8)
    v_mfma_f32_32x32x16_bf16 v[144:159], v[24:27], a[48:51], v[144:159]
    ds_read_b64_tr_b16 v[44:45], v22 offset:17408
    ds_read_b64_tr_b16 v[46:47], v22 offset:17664
    s_waitcnt lgkmcnt(8)
    v_mfma_f32_32x32x16_bf16 v[144:159], v[28:31], a[52:55], v[144:159]
    ds_read_b64_tr_b16 v[24:25], v22 offset:18432
    ds_read_b64_tr_b16 v[26:27], v22 offset:18688
    s_waitcnt lgkmcnt(8)
    v_mfma_f32_32x32x16_bf16 v[144:159], v[32:35], a[56:59], v[144:159]
    ds_read_b64_tr_b16 v[28:29], v22 offset:19456
    ds_read_b64_tr_b16 v[30:31], v22 offset:19712
    s_waitcnt lgkmcnt(8)
    v_mfma_f32_32x32x16_bf16 v[144:159], v[36:39], a[60:63], v[144:159]
    ds_read_b64_tr_b16 v[32:33], v22 offset:20480
    ds_read_b64_tr_b16 v[34:35], v22 offset:20736
    s_waitcnt lgkmcnt(8)
    v_mfma_f32_32x32x16_bf16 v[144:159], v[40:43], a[64:67], v[144:159]
    ds_read_b64_tr_b16 v[36:37], v22 offset:21504
    ds_read_b64_tr_b16 v[38:39], v22 offset:21760
    s_waitcnt lgkmcnt(8)
    v_mfma_f32_32x32x16_bf16 v[144:159], v[44:47], a[68:71], v[144:159]
    ds_read_b64_tr_b16 v[40:41], v22 offset:22528
    ds_read_b64_tr_b16 v[42:43], v22 offset:22784
    s_waitcnt lgkmcnt(8)
    v_mfma_f32_32x32x16_bf16 v[144:159], v[24:27], a[72:75], v[144:159]
    ds_read_b64_tr_b16 v[44:45], v22 offset:23552
    ds_read_b64_tr_b16 v[46:47], v22 offset:23808
    s_waitcnt lgkmcnt(8)
    v_mfma_f32_32x32x16_bf16 v[144:159], v[28:31], a[76:79], v[144:159]
    s_waitcnt vmcnt(5)
    s_barrier
    ds_read_b64_tr_b16 v[24:25], v22 offset:24576
    ds_read_b64_tr_b16 v[26:27], v22 offset:24832
    s_waitcnt lgkmcnt(8)
    v_mfma_f32_32x32x16_bf16 v[144:159], v[32:35], a[80:83], v[144:159]
    ds_read_b64_tr_b16 v[28:29], v22 offset:25600
    ds_read_b64_tr_b16 v[30:31], v22 offset:25856
    s_waitcnt lgkmcnt(8)
    v_mfma_f32_32x32x16_bf16 v[144:159], v[36:39], a[84:87], v[144:159]
    ds_read_b64_tr_b16 v[32:33], v22 offset:26624
    ds_read_b64_tr_b16 v[34:35], v22 offset:26880
    s_waitcnt lgkmcnt(8)
    v_mfma_f32_32x32x16_bf16 v[144:159], v[40:43], a[88:91], v[144:159]
    ds_read_b64_tr_b16 v[36:37], v22 offset:27648
    ds_read_b64_tr_b16 v[38:39], v22 offset:27904
    s_waitcnt lgkmcnt(8)
    v_mfma_f32_32x32x16_bf16 v[144:159], v[44:47], a[92:95], v[144:159]
    s_waitcnt lgkmcnt(6)
    v_mfma_f32_32x32x16_bf16 v[144:159], v[24:27], a[96:99], v[144:159]
    s_waitcnt lgkmcnt(4)
    v_mfma_f32_32x32x16_bf16 v[144:159], v[28:31], a[100:103], v[144:159]
    s_waitcnt lgkmcnt(2)
    v_mfma_f32_32x32x16_bf16 v[144:159], v[32:35], a[104:107], v[144:159]
    s_waitcnt lgkmcnt(0)
    v_mfma_f32_32x32x16_bf16 v[144:159], v[36:39], a[108:111], v[144:159]
    s_nop 11
    v_pk_mul_f32 v[144:145], v[144:145], s[66:67]
    v_pk_mul_f32 v[146:147], v[146:147], s[66:67]
    v_pk_mul_f32 v[148:149], v[148:149], s[66:67]
    v_pk_mul_f32 v[150:151], v[150:151], s[66:67]
    v_cvt_pk_bf16_f32 v72, v144, v145
    v_cvt_pk_bf16_f32 v74, v148, v149
    v_cvt_pk_bf16_f32 v73, v146, v147
    v_cvt_pk_bf16_f32 v75, v150, v151
    v_permlane32_swap_b32 v72, v74
    s_cmp_lg_u64 s[54:55], 0
    v_permlane32_swap_b32 v73, v75
    s_cbranch_scc1 P1_QQQ_x20
P1_QQQ_e20:
    buffer_store_dwordx4 v[72:75], v104, s[16:19], s60 offen sc1
    v_pk_mul_f32 v[152:153], v[152:153], s[66:67]
    v_pk_mul_f32 v[154:155], v[154:155], s[66:67]
    v_pk_mul_f32 v[156:157], v[156:157], s[66:67]
    v_pk_mul_f32 v[158:159], v[158:159], s[66:67]
    v_cvt_pk_bf16_f32 v76, v152, v153
    v_cvt_pk_bf16_f32 v78, v156, v157
    v_cvt_pk_bf16_f32 v77, v154, v155
    v_cvt_pk_bf16_f32 v79, v158, v159
    v_permlane32_swap_b32 v76, v78
    s_cmp_lg_u64 s[56:57], 0
    v_permlane32_swap_b32 v77, v79
    s_cbranch_scc1 P1_QQQ_x21
P1_QQQ_e21:
    buffer_store_dwordx4 v[76:79], v105, s[16:19], s60 offen sc1
    s_branch P1_done
P1_QQQ_x00:
    s_mov_b64 exec, s[46:47]
    v_mov_b32 v96, v58
    v_mov_b32 v97, v59
    v_mov_b32 v58, v98
    v_mov_b32 v59, 0
    buffer_store_dwordx4 v[96:99], v100, s[16:19], s86 offen sc1
    s_mov_b64 exec, -1
    s_branch P1_QQQ_e00
P1_QQQ_x01:
    s_mov_b64 exec, s[48:49]
    v_mov_b32 v96, v62
    v_mov_b32 v97, v63
    v_mov_b32 v62, v98
    v_mov_b32 v63, 0
    buffer_store_dwordx4 v[96:99], v101, s[16:19], s86 offen sc1
    s_mov_b64 exec, -1
    s_branch P1_QQQ_e01
P1_QQQ_x10:
    s_mov_b64 exec, s[50:51]
    v_mov_b32 v96, v66
    v_mov_b32 v97, v67
    v_mov_b32 v66, v98
    v_mov_b32 v67, 0
    buffer_store_dwordx4 v[96:99], v102, s[16:19], s87 offen sc1
    s_mov_b64 exec, -1
    s_branch P1_QQQ_e10
P1_QQQ_x11:
    s_mov_b64 exec, s[52:53]
    v_mov_b32 v96, v70
    v_mov_b32 v97, v71
    v_mov_b32 v70, v98
    v_mov_b32 v71, 0
    buffer_store_dwordx4 v[96:99], v103, s[16:19], s87 offen sc1
    s_mov_b64 exec, -1
    s_branch P1_QQQ_e11
P1_QQQ_x20:
    s_mov_b64 exec, s[54:55]
    v_mov_b32 v96, v74
    v_mov_b32 v97, v75
    v_mov_b32 v74, v98
    v_mov_b32 v75, 0
    buffer_store_dwordx4 v[96:99], v104, s[16:19], s88 offen sc1
    s_mov_b64 exec, -1
    s_branch P1_QQQ_e20
P1_QQQ_x21:
    s_mov_b64 exec, s[56:57]
    v_mov_b32 v96, v78
    v_mov_b32 v97, v79
    v_mov_b32 v78, v98
    v_mov_b32 v79, 0
    buffer_store_dwordx4 v[96:99], v105, s[16:19], s88 offen sc1
    s_mov_b64 exec, -1
    s_branch P1_QQQ_e21
P1_VVQ:
    s_add_u32 m0, s45, 0
    s_nop 0
    buffer_load_dwordx4 v13, s[12:15], s72 offen lds
    s_lshl_b32 s42, s27, 11
    s_add_u32 s42, s42, 1048576
    s_lshl_b32 s43, s27, 12
    s_add_u32 s43, s43, 3145728
    s_mul_i32 s38, s24, 3
    s_add_u32 s38, s38, s44
    s_lshl_b32 s3, s24, 4
    s_add_u32 s3, s3, s25
    s_lshl_b32 s3, s3, 7
    s_add_u32 s3, s3, 32768
    v_and_b32 v23, 0x13, v5
    v_bfe_u32 v2, v1, 2, 1
    v_lshl_or_b32 v23, v2, 3, v23
    v_bfe_u32 v2, v1, 3, 1
    v_lshl_or_b32 v23, v2, 2, v23
    v_lshlrev_b32 v23, 4, v23
    v_mov_b32 v98, 0x3f80
    v_mov_b32 v99, 0
    v_cmp_eq_u32 vcc, 0, v7
    v_mov_b32 v2, 0x3f803f80
    s_nop 0
    v_cndmask_b32 v92, 0, v2, vcc
    v_mov_b32 v93, v92
    v_mov_b32 v94, v92
    v_mov_b32 v95, v92
    s_add_u32 s39, s38, -28
    s_lshl_b32 s41, s39, 3
    v_add_u32 v2, s41, v6
    v_mul_u32_u24 v2, 147, v2
    v_lshrrev_b32 v2, 10, v2
    v_lshlrev_b32 v2, 18, v2
    v_bfe_u32 v3, v1, 2, 2
    v_lshl_add_u32 v2, v3, 9, v2
    v_lshl_add_u32 v2, v7, 4, v2
    v_add_u32 v101, 2496, v2
    s_lshl_b32 s39, s39, 5
    v_add_u32 v2, s39, v5
    v_mul_u32_u24 v3, 2341, v2
    v_lshrrev_b32 v3, 16, v3
    v_mul_u32_u24 v4, 28, v3
    v_sub_u32 v2, v2, v4
    v_lshlrev_b32 v3, 18, v3
    v_lshl_add_u32 v3, v2, 4, v3
    v_lshl_add_u32 v100, v6, 9, v3
    s_add_u32 s39, s38, -27
    s_lshl_b32 s41, s39, 3
    v_add_u32 v2, s41, v6
    v_mul_u32_u24 v2, 147, v2
    v_lshrrev_b32 v2, 10, v2
    v_lshlrev_b32 v2, 18, v2
    v_bfe_u32 v3, v1, 2, 2
    v_lshl_add_u32 v2, v3, 9, v2
    v_lshl_add_u32 v2, v7, 4, v2
    v_add_u32 v103, 2496, v2
    s_lshl_b32 s39, s39, 5
    v_add_u32 v2, s39, v5
    v_mul_u32_u24 v3, 2341, v2
    v_lshrrev_b32 v3, 16, v3
    v_mul_u32_u24 v4, 28, v3
    v_sub_u32 v2, v2, v4
    v_lshlrev_b32 v3, 18, v3
    v_lshl_add_u32 v3, v2, 4, v3
    v_lshl_add_u32 v102, v6, 9, v3
    s_mul_i32 s39, s44, 3
    s_sub_u32 s39, s38, s39
    s_add_u32 s39, s39, 2
    s_add_u32 s41, s39, 2
    s_lshr_b32 s41, s41, 4
    s_sub_u32 s40, s43, s42
    s_mul_i32 s40, s40, s41
    s_add_u32 s60, s42, s40
    s_mul_i32 s40, s41, 0xf4680a
    s_add_u32 s66, s40, 0x3e8b97f6
    s_mov_b32 s67, s66
    s_add_u32 s40, s41, 17
    s_mul_i32 s41, s41, 14
    s_sub_u32 s39, s39, s41
    s_lshl_b32 s41, 1, s40
    s_add_u32 s88, s60, s41
    s_lshl_b32 s39, s39, 2
    v_add_u32 v2, s39, v6
    v_mul_u32_u24 v3, 37, v2
    v_lshrrev_b32 v3, 8, v3
    v_mul_u32_u24 v4, 7, v3
    v_sub_u32 v2, v2, v4
    v_lshrrev_b32 v4, 2, v2
    v_lshl_add_u32 v3, v3, 1, v4
    v_lshl_add_u32 v3, v3, s40, v23
    v_cmp_eq_u32 s[54:55], 3, v2
    v_and_b32 v2, 3, v2
    v_lshl_add_u32 v104, v2, 9, v3
    s_add_u32 s39, s39, 2
    v_add_u32 v2, s39, v6
    v_mul_u32_u24 v3, 37, v2
    v_lshrrev_b32 v3, 8, v3
    v_mul_u32_u24 v4, 7, v3
    v_sub_u32 v2, v2, v4
    v_lshrrev_b32 v4, 2, v2
    v_lshl_add_u32 v3, v3, 1, v4
    v_lshl_add_u32 v3, v3, s40, v23
    v_cmp_eq_u32 s[56:57], 3, v2
    v_and_b32 v2, 3, v2
    v_lshl_add_u32 v105, v2, 9, v3
    s_lshr_b32 s100, s2, 4
    s_lshl_b32 s100, s100, 2
    s_add_u32 s100, s100, s26
    s_lshl_b32 s100, s100, 3
    s_and_b32 s101, s2, 7
    s_add_u32 s100, s100, s101
    s_lshl_b32 s100, s100, 1
    s_and_b32 s101, s29, 1
    s_add_u32 s100, s100, s101
    s_lshl_b32 s101, s100, 11
    s_add_u32 s101, s101, 7340032
    v_lshrrev_b32 v2, 3, v0
    v_min_u32 v2, 1, v2
    v_lshlrev_b32 v3, 4, v1
    v_lshl_or_b32 v85, v2, 30, v3
    v_mov_b32 v80, -1
    v_mov_b32 v81, -1
    v_mov_b32 v82, -1
    v_mov_b32 v83, -1
    s_waitcnt lgkmcnt(0)
    s_mul_i32 s68, s68, 1664525
    s_add_u32 s68, s68, 1013904223
    s_mul_i32 s69, s69, 22695477
    s_add_u32 s69, s69, 1
    s_waitcnt vmcnt(7)
    s_barrier
    ds_read_b128 a[0:3], v16 offset:0
    ds_read_b64_tr_b16 v[24:25], v20 offset:0
    ds_read_b64_tr_b16 v[26:27], v20 offset:512
    ds_read_b64_tr_b16 v[28:29], v21 offset:0
    ds_read_b64_tr_b16 v[30:31], v21 offset:512
    ds_read_b128 a[4:7], v17 offset:0
    ds_read_b64_tr_b16 v[32:33], v20 offset:2048
    ds_read_b64_tr_b16 v[34:35], v20 offset:2560
    ds_read_b64_tr_b16 v[36:37], v21 offset:2048
    ds_read_b64_tr_b16 v[38:39], v21 offset:2560
    s_add_u32 m0, s36, 16384
    s_waitcnt lgkmcnt(7)
    v_mfma_f32_32x32x16_bf16 v[112:127], a[0:3], v[24:27], 0
    buffer_load_dwordx4 v12, s[12:15], s76 offen lds
    ds_read_b128 a[8:11], v18 offset:0
    ds_read_b64_tr_b16 v[40:41], v20 offset:4096
    ds_read_b64_tr_b16 v[42:43], v20 offset:4608
    s_add_u32 m0, s36, 17408
    s_waitcnt lgkmcnt(8)
    v_mfma_f32_32x32x16_bf16 v[128:143], a[0:3], v[28:31], 0
    buffer_load_dwordx4 v14, s[12:15], s76 offen lds
    ds_read_b64_tr_b16 v[44:45], v21 offset:4096
    ds_read_b64_tr_b16 v[46:47], v21 offset:4608
    s_add_u32 m0, s35, 8192
    s_waitcnt lgkmcnt(7)
    v_mfma_f32_32x32x16_bf16 v[112:127], a[4:7], v[32:35], v[112:127]
    buffer_load_dwordx4 v8, s[8:11], s77 offen lds
    ds_read_b128 a[12:15], v19 offset:0
    ds_read_b64_tr_b16 v[24:25], v20 offset:6144
    ds_read_b64_tr_b16 v[26:27], v20 offset:6656
    s_add_u32 m0, s35, 9216
    s_waitcnt lgkmcnt(8)
    v_mfma_f32_32x32x16_bf16 v[128:143], a[4:7], v[36:39], v[128:143]
    buffer_load_dwordx4 v9, s[8:11], s77 offen lds
    ds_read_b64_tr_b16 v[28:29], v21 offset:6144
    ds_read_b64_tr_b16 v[30:31], v21 offset:6656
    s_add_u32 m0, s35, 10240
    s_waitcnt lgkmcnt(7)
    v_mfma_f32_32x32x16_bf16 v[112:127], a[8:11], v[40:43], v[112:127]
    buffer_load_dwordx4 v10, s[8:11], s77 offen lds
    s_waitcnt vmcnt(6)
    s_barrier
    ds_read_b128 a[16:19], v16 offset:4096
    ds_read_b64_tr_b16 v[32:33], v20 offset:8192
    ds_read_b64_tr_b16 v[34:35], v20 offset:8704
    s_add_u32 m0, s35, 11264
    s_waitcnt lgkmcnt(8)
    v_mfma_f32_32x32x16_bf16 v[128:143], a[8:11], v[44:47], v[128:143]
    buffer_load_dwordx4 v11, s[8:11], s77 offen lds
    ds_read_b64_tr_b16 v[36:37], v21 offset:8192
    ds_read_b64_tr_b16 v[38:39], v21 offset:8704
    s_add_u32 m0, s36, 24576
    s_waitcnt lgkmcnt(7)
    v_mfma_f32_32x32x16_bf16 v[112:127], a[12:15], v[24:27], v[112:127]
    buffer_load_dwordx4 v12, s[12:15], s78 offen lds
    ds_read_b128 a[20:23], v17 offset:4096
    ds_read_b64_tr_b16 v[40:41], v20 offset:10240
    ds_read_b64_tr_b16 v[42:43], v20 offset:10752
    s_add_u32 m0, s36, 25600
    s_waitcnt lgkmcnt(8)
    v_mfma_f32_32x32x16_bf16 v[128:143], a[12:15], v[28:31], v[128:143]
    buffer_load_dwordx4 v14, s[12:15], s78 offen lds
    ds_read_b64_tr_b16 v[44:45], v21 offset:10240
    ds_read_b64_tr_b16 v[46:47], v21 offset:10752
    s_add_u32 m0, s35, 12288
    s_waitcnt lgkmcnt(7)
    v_mfma_f32_32x32x16_bf16 v[112:127], a[16:19], v[32:35], v[112:127]
    buffer_load_dwordx4 v8, s[8:11], s79 offen lds
    ds_read_b128 a[24:27], v18 offset:4096
    ds_read_b64_tr_b16 v[24:25], v20 offset:12288
    ds_read_b64_tr_b16 v[26:27], v20 offset:12800
    s_add_u32 m0, s35, 13312
    s_waitcnt lgkmcnt(8)
    v_mfma_f32_32x32x16_bf16 v[128:143], a[16:19], v[36:39], v[128:143]
    buffer_load_dwordx4 v9, s[8:11], s79 offen lds
    ds_read_b64_tr_b16 v[28:29], v21 offset:12288
    ds_read_b64_tr_b16 v[30:31], v21 offset:12800
    s_add_u32 m0, s35, 14336
    s_waitcnt lgkmcnt(7)
    v_mfma_f32_32x32x16_bf16 v[112:127], a[20:23], v[40:43], v[112:127]
    buffer_load_dwordx4 v10, s[8:11], s79 offen lds
    ds_read_b128 a[28:31], v19 offset:4096
    ds_read_b64_tr_b16 v[32:33], v20 offset:14336
    ds_read_b64_tr_b16 v[34:35], v20 offset:14848
    s_add_u32 m0, s35, 15360
    s_waitcnt lgkmcnt(8)
    v_mfma_f32_32x32x16_bf16 v[128:143], a[20:23], v[44:47], v[128:143]
    buffer_load_dwordx4 v11, s[8:11], s79 offen lds
    ds_read_b64_tr_b16 v[36:37], v21 offset:14336
    ds_read_b64_tr_b16 v[38:39], v21 offset:14848
    s_add_u32 m0, s36, 32768
    s_waitcnt lgkmcnt(7)
    v_mfma_f32_32x32x16_bf16 v[112:127], a[24:27], v[24:27], v[112:127]
    buffer_load_dwordx4 v12, s[12:15], s80 offen lds
    s_waitcnt vmcnt(7)
    s_barrier
    ds_read_b128 a[32:35], v16 offset:8192
    ds_read_b64_tr_b16 v[40:41], v20 offset:16384
    ds_read_b64_tr_b16 v[42:43], v20 offset:16896
    s_add_u32 m0, s36, 33792
    s_waitcnt lgkmcnt(8)
    v_mfma_f32_32x32x16_bf16 v[128:143], a[24:27], v[28:31], v[128:143]
    buffer_load_dwordx4 v14, s[12:15], s80 offen lds
    ds_read_b64_tr_b16 v[44:45], v21 offset:16384
    ds_read_b64_tr_b16 v[46:47], v21 offset:16896
    s_add_u32 m0, s35, 0
    s_waitcnt lgkmcnt(7)
    v_mfma_f32_32x32x16_bf16 v[112:127], a[28:31], v[32:35], v[112:127]
    buffer_load_dwordx4 v8, s[8:11], s81 offen lds
    ds_read_b128 a[36:39], v17 offset:8192
    ds_read_b64_tr_b16 v[24:25], v20 offset:18432
    ds_read_b64_tr_b16 v[26:27], v20 offset:18944
    s_add_u32 m0, s35, 1024
    s_waitcnt lgkmcnt(8)
    v_mfma_f32_32x32x16_bf16 v[128:143], a[28:31], v[36:39], v[128:143]
    buffer_load_dwordx4 v9, s[8:11], s81 offen lds
    ds_read_b64_tr_b16 v[28:29], v21 offset:18432
    ds_read_b64_tr_b16 v[30:31], v21 offset:18944
    s_add_u32 m0, s35, 2048
    s_waitcnt lgkmcnt(7)
    v_mfma_f32_32x32x16_bf16 v[112:127], a[32:35], v[40:43], v[112:127]
    buffer_load_dwordx4 v10, s[8:11], s81 offen lds
    ds_read_b128 a[40:43], v18 offset:8192
    ds_read_b64_tr_b16 v[32:33], v20 offset:20480
    ds_read_b64_tr_b16 v[34:35], v20 offset:20992
    s_add_u32 m0, s35, 3072
    s_waitcnt lgkmcnt(8)
    v_mfma_f32_32x32x16_bf16 v[128:143], a[32:35], v[44:47], v[128:143]
    buffer_load_dwordx4 v11, s[8:11], s81 offen lds
    ds_read_b64_tr_b16 v[36:37], v21 offset:20480
    ds_read_b64_tr_b16 v[38:39], v21 offset:20992
    s_add_u32 m0, s36, 40960
    s_waitcnt lgkmcnt(7)
    v_mfma_f32_32x32x16_bf16 v[112:127], a[36:39], v[24:27], v[112:127]
    buffer_load_dwordx4 v12, s[12:15], s82 offen lds
    ds_read_b128 a[44:47], v19 offset:8192
    ds_read_b64_tr_b16 v[40:41], v20 offset:22528
    ds_read_b64_tr_b16 v[42:43], v20 offset:23040
    s_add_u32 m0, s36, 41984
    s_waitcnt lgkmcnt(8)
    v_mfma_f32_32x32x16_bf16 v[128:143], a[36:39], v[28:31], v[128:143]
    buffer_load_dwordx4 v14, s[12:15], s82 offen lds
    ds_read_b64_tr_b16 v[44:45], v21 offset:22528
    ds_read_b64_tr_b16 v[46:47], v21 offset:23040
    s_add_u32 m0, s35, 4096
    s_waitcnt lgkmcnt(7)
    v_mfma_f32_32x32x16_bf16 v[112:127], a[40:43], v[32:35], v[112:127]
    buffer_load_dwordx4 v8, s[8:11], s83 offen lds
    s_waitcnt vmcnt(9)
    s_barrier
    ds_read_b128 a[48:51], v16 offset:12288
    ds_read_b64_tr_b16 v[24:25], v20 offset:24576
    ds_read_b64_tr_b16 v[26:27], v20 offset:25088
    s_add_u32 m0, s35, 5120
    s_waitcnt lgkmcnt(8)
    v_mfma_f32_32x32x16_bf16 v[128:143], a[40:43], v[36:39], v[128:143]
    buffer_load_dwordx4 v9, s[8:11], s83 offen lds
    ds_read_b64_tr_b16 v[28:29], v21 offset:24576
    ds_read_b64_tr_b16 v[30:31], v21 offset:25088
    s_add_u32 m0, s35, 6144
    s_waitcnt lgkmcnt(7)
    v_mfma_f32_32x32x16_bf16 v[112:127], a[44:47], v[40:43], v[112:127]
    buffer_load_dwordx4 v10, s[8:11], s83 offen lds
    ds_read_b128 a[52:55], v17 offset:12288
    ds_read_b64_tr_b16 v[32:33], v20 offset:26624
    ds_read_b64_tr_b16 v[34:35], v20 offset:27136
    s_add_u32 m0, s35, 7168
    s_waitcnt lgkmcnt(8)
    v_mfma_f32_32x32x16_bf16 v[128:143], a[44:47], v[44:47], v[128:143]
    buffer_load_dwordx4 v11, s[8:11], s83 offen lds
    ds_read_b64_tr_b16 v[36:37], v21 offset:26624
    ds_read_b64_tr_b16 v[38:39], v21 offset:27136
    s_add_u32 m0, s36, 49152
    s_waitcnt lgkmcnt(7)
    v_mfma_f32_32x32x16_bf16 v[112:127], a[48:51], v[24:27], v[112:127]
    buffer_load_dwordx4 v12, s[12:15], s84 offen lds
    ds_read_b128 a[56:59], v18 offset:12288
    ds_read_b64_tr_b16 v[40:41], v20 offset:28672
    ds_read_b64_tr_b16 v[42:43], v20 offset:29184
    s_add_u32 m0, s36, 50176
    s_waitcnt lgkmcnt(8)
    v_mfma_f32_32x32x16_bf16 v[128:143], a[48:51], v[28:31], v[128:143]
    buffer_load_dwordx4 v14, s[12:15], s84 offen lds
    ds_read_b64_tr_b16 v[44:45], v21 offset:28672
    ds_read_b64_tr_b16 v[46:47], v21 offset:29184
    s_add_u32 m0, s35, 8192
    s_waitcnt lgkmcnt(7)
    v_mfma_f32_32x32x16_bf16 v[112:127], a[52:55], v[32:35], v[112:127]
    buffer_load_dwordx4 v8, s[8:11], s85 offen lds
    ds_read_b128 a[60:63], v19 offset:12288
    ds_read_b64_tr_b16 v[24:25], v20 offset:30720
    ds_read_b64_tr_b16 v[26:27], v20 offset:31232
    s_add_u32 m0, s35, 9216
    s_waitcnt lgkmcnt(8)
    v_mfma_f32_32x32x16_bf16 v[128:143], a[52:55], v[36:39], v[128:143]
    buffer_load_dwordx4 v9, s[8:11], s85 offen lds
    ds_read_b64_tr_b16 v[28:29], v21 offset:30720
    ds_read_b64_tr_b16 v[30:31], v21 offset:31232
    s_add_u32 m0, s35, 10240
    s_waitcnt lgkmcnt(7)
    v_mfma_f32_32x32x16_bf16 v[112:127], a[56:59], v[40:43], v[112:127]
    buffer_load_dwordx4 v10, s[8:11], s85 offen lds
    s_waitcnt vmcnt(11)
    s_barrier
    ds_read_b128 a[64:67], v16 offset:0
    ds_read_b64_tr_b16 v[32:33], v20 offset:32768
    ds_read_b64_tr_b16 v[34:35], v20 offset:33280
    s_add_u32 m0, s35, 11264
    s_waitcnt lgkmcnt(8)
    v_mfma_f32_32x32x16_bf16 v[128:143], a[56:59], v[44:47], v[128:143]
    buffer_load_dwordx4 v11, s[8:11], s85 offen lds
    ds_read_b64_tr_b16 v[36:37], v21 offset:32768
    ds_read_b64_tr_b16 v[38:39], v21 offset:33280
    s_add_u32 m0, s45, 4096
    s_waitcnt lgkmcnt(7)
    v_mfma_f32_32x32x16_bf16 v[112:127], a[60:63], v[24:27], v[112:127]
    buffer_load_dwordx4 v13, s[12:15], s74 offen lds
    ds_read_b128 a[68:71], v17 offset:0
    ds_read_b64_tr_b16 v[40:41], v20 offset:34816
    ds_read_b64_tr_b16 v[42:43], v20 offset:35328
    s_add_u32 m0, s45, 8192
    s_waitcnt lgkmcnt(8)
    v_mfma_f32_32x32x16_bf16 v[128:143], a[60:63], v[28:31], v[128:143]
    buffer_load_dwordx4 v13, s[12:15], s76 offen lds
    ds_read_b64_tr_b16 v[44:45], v21 offset:34816
    ds_read_b64_tr_b16 v[46:47], v21 offset:35328
    s_add_u32 m0, s45, 12288
    s_waitcnt lgkmcnt(7)
    v_mfma_f32_32x32x16_bf16 v[112:127], a[64:67], v[32:35], v[112:127]
    buffer_load_dwordx4 v13, s[12:15], s78 offen lds
    ds_read_b128 a[72:75], v18 offset:0
    ds_read_b64_tr_b16 v[24:25], v20 offset:36864
    ds_read_b64_tr_b16 v[26:27], v20 offset:37376
    s_add_u32 m0, s45, 16384
    s_waitcnt lgkmcnt(8)
    v_mfma_f32_32x32x16_bf16 v[128:143], a[64:67], v[36:39], v[128:143]
    buffer_load_dwordx4 v13, s[12:15], s80 offen lds
    ds_read_b64_tr_b16 v[28:29], v21 offset:36864
    ds_read_b64_tr_b16 v[30:31], v21 offset:37376
    s_add_u32 m0, s45, 20480
    s_waitcnt lgkmcnt(7)
    v_mfma_f32_32x32x16_bf16 v[112:127], a[68:71], v[40:43], v[112:127]
    buffer_load_dwordx4 v13, s[12:15], s82 offen lds
    ds_read_b128 a[76:79], v19 offset:0
    ds_read_b64_tr_b16 v[32:33], v20 offset:38912
    ds_read_b64_tr_b16 v[34:35], v20 offset:39424
    s_add_u32 m0, s45, 24576
    s_waitcnt lgkmcnt(8)
    v_mfma_f32_32x32x16_bf16 v[128:143], a[68:71], v[44:47], v[128:143]
    buffer_load_dwordx4 v13, s[12:15], s84 offen lds
    ds_read_b64_tr_b16 v[36:37], v21 offset:38912
    ds_read_b64_tr_b16 v[38:39], v21 offset:39424
    s_waitcnt lgkmcnt(7)
    v_mfma_f32_32x32x16_bf16 v[112:127], a[72:75], v[24:27], v[112:127]
    s_waitcnt vmcnt(12)
    s_barrier
    ds_read_b128 a[80:83], v16 offset:4096
    ds_read_b64_tr_b16 v[40:41], v20 offset:40960
    ds_read_b64_tr_b16 v[42:43], v20 offset:41472
    buffer_store_dwordx4 v[80:83], v85, s[16:19], s3 offen sc1
    s_waitcnt lgkmcnt(8)
    v_mfma_f32_32x32x16_bf16 v[128:143], a[72:75], v[28:31], v[128:143]
    ds_read_b64_tr_b16 v[44:45], v21 offset:40960
    ds_read_b64_tr_b16 v[46:47], v21 offset:41472
    s_waitcnt lgkmcnt(7)
    v_mfma_f32_32x32x16_bf16 v[112:127], a[76:79], v[32:35], v[112:127]
    ds_read_b128 a[84:87], v17 offset:4096
    ds_read_b64_tr_b16 v[24:25], v20 offset:43008
    ds_read_b64_tr_b16 v[26:27], v20 offset:43520
    s_waitcnt lgkmcnt(8)
    v_mfma_f32_32x32x16_bf16 v[128:143], a[76:79], v[36:39], v[128:143]
    ds_read_b64_tr_b16 v[28:29], v21 offset:43008
    ds_read_b64_tr_b16 v[30:31], v21 offset:43520
    s_waitcnt lgkmcnt(7)
    v_mfma_f32_32x32x16_bf16 v[112:127], a[80:83], v[40:43], v[112:127]
    ds_read_b128 a[88:91], v18 offset:4096
    ds_read_b64_tr_b16 v[32:33], v20 offset:45056
    ds_read_b64_tr_b16 v[34:35], v20 offset:45568
    s_waitcnt lgkmcnt(8)
    v_mfma_f32_32x32x16_bf16 v[128:143], a[80:83], v[44:47], v[128:143]
    ds_read_b64_tr_b16 v[36:37], v21 offset:45056
    ds_read_b64_tr_b16 v[38:39], v21 offset:45568
    s_waitcnt lgkmcnt(7)
    v_mfma_f32_32x32x16_bf16 v[112:127], a[84:87], v[24:27], v[112:127]
    ds_read_b128 a[92:95], v19 offset:4096
    ds_read_b64_tr_b16 v[40:41], v20 offset:47104
    ds_read_b64_tr_b16 v[42:43], v20 offset:47616
    s_waitcnt lgkmcnt(8)
    v_mfma_f32_32x32x16_bf16 v[128:143], a[84:87], v[28:31], v[128:143]
    ds_read_b64_tr_b16 v[44:45], v21 offset:47104
    ds_read_b64_tr_b16 v[46:47], v21 offset:47616
    s_waitcnt lgkmcnt(7)
    v_mfma_f32_32x32x16_bf16 v[112:127], a[88:91], v[32:35], v[112:127]
    s_waitcnt vmcnt(7)
    s_barrier
    ds_read_b128 a[96:99], v16 offset:8192
    ds_read_b64_tr_b16 v[24:25], v20 offset:49152
    ds_read_b64_tr_b16 v[26:27], v20 offset:49664
    s_waitcnt lgkmcnt(8)
    v_mfma_f32_32x32x16_bf16 v[128:143], a[88:91], v[36:39], v[128:143]
    ds_read_b64_tr_b16 v[28:29], v21 offset:49152
    ds_read_b64_tr_b16 v[30:31], v21 offset:49664
    s_waitcnt lgkmcnt(7)
    v_mfma_f32_32x32x16_bf16 v[112:127], a[92:95], v[40:43], v[112:127]
    ds_read_b128 a[100:103], v17 offset:8192
    ds_read_b64_tr_b16 v[32:33], v20 offset:51200
    ds_read_b64_tr_b16 v[34:35], v20 offset:51712
    s_waitcnt lgkmcnt(8)
    v_mfma_f32_32x32x16_bf16 v[128:143], a[92:95], v[44:47], v[128:143]
    ds_read_b64_tr_b16 v[36:37], v21 offset:51200
    ds_read_b64_tr_b16 v[38:39], v21 offset:51712
    s_waitcnt lgkmcnt(7)
    v_mfma_f32_32x32x16_bf16 v[112:127], a[96:99], v[24:27], v[112:127]
    ds_read_b128 a[104:107], v18 offset:8192
    ds_read_b64_tr_b16 v[40:41], v20 offset:53248
    ds_read_b64_tr_b16 v[42:43], v20 offset:53760
    s_waitcnt lgkmcnt(8)
    v_mfma_f32_32x32x16_bf16 v[128:143], a[96:99], v[28:31], v[128:143]
    ds_read_b64_tr_b16 v[44:45], v21 offset:53248
    ds_read_b64_tr_b16 v[46:47], v21 offset:53760
    s_waitcnt lgkmcnt(7)
    v_mfma_f32_32x32x16_bf16 v[112:127], a[100:103], v[32:35], v[112:127]
    ds_read_b128 a[108:111], v19 offset:8192
    ds_read_b64_tr_b16 v[24:25], v20 offset:55296
    ds_read_b64_tr_b16 v[26:27], v20 offset:55808
    s_waitcnt lgkmcnt(8)
    v_mfma_f32_32x32x16_bf16 v[128:143], a[100:103], v[36:39], v[128:143]
    ds_read_b64_tr_b16 v[28:29], v21 offset:55296
    ds_read_b64_tr_b16 v[30:31], v21 offset:55808
    s_waitcnt lgkmcnt(7)
    v_mfma_f32_32x32x16_bf16 v[112:127], a[104:107], v[40:43], v[112:127]
    s_waitcnt lgkmcnt(5)
    v_mfma_f32_32x32x16_bf16 v[128:143], a[104:107], v[44:47], v[128:143]
    s_waitcnt lgkmcnt(2)
    v_mfma_f32_32x32x16_bf16 v[112:127], a[108:111], v[24:27], v[112:127]
    s_waitcnt lgkmcnt(0)
    v_mfma_f32_32x32x16_bf16 v[128:143], a[108:111], v[28:31], v[128:143]
    s_waitcnt vmcnt(5)
    s_barrier
    ds_read_b64_tr_b16 v[24:25], v22 offset:0
    ds_read_b64_tr_b16 v[26:27], v22 offset:256
    ds_read_b64_tr_b16 v[28:29], v22 offset:1024
    ds_read_b64_tr_b16 v[30:31], v22 offset:1280
    ds_read_b64_tr_b16 v[32:33], v22 offset:2048
    ds_read_b64_tr_b16 v[34:35], v22 offset:2304
    ds_read_b64_tr_b16 v[36:37], v22 offset:3072
    ds_read_b64_tr_b16 v[38:39], v22 offset:3328
    ds_read_b64_tr_b16 v[40:41], v22 offset:4096
    ds_read_b64_tr_b16 v[42:43], v22 offset:4352
    s_waitcnt lgkmcnt(8)
    v_mfma_f32_32x32x16_bf16 v[144:159], v[24:27], a[0:3], 0
    ds_read_b64_tr_b16 v[44:45], v22 offset:5120
    ds_read_b64_tr_b16 v[46:47], v22 offset:5376
    buffer_store_dwordx4 v[92:95], v101, s[16:19], s43 offen sc1
    buffer_store_dwordx4 v[92:95], v103, s[16:19], s43 offen sc1
    v_cvt_pk_bf16_f32 v56, v112, v113
    s_waitcnt lgkmcnt(8)
    v_mfma_f32_32x32x16_bf16 v[144:159], v[28:31], a[4:7], v[144:159]
    ds_read_b64_tr_b16 v[24:25], v22 offset:6144
    ds_read_b64_tr_b16 v[26:27], v22 offset:6400
    v_cvt_pk_bf16_f32 v57, v114, v115
    v_cvt_pk_bf16_f32 v58, v116, v117
    v_cvt_pk_bf16_f32 v59, v118, v119
    s_waitcnt lgkmcnt(8)
    v_mfma_f32_32x32x16_bf16 v[144:159], v[32:35], a[8:11], v[144:159]
    ds_read_b64_tr_b16 v[28:29], v22 offset:7168
    ds_read_b64_tr_b16 v[30:31], v22 offset:7424
    buffer_store_dwordx4 v[56:59], v100, s[16:19], s43 offen offset:2048 sc1
    v_cvt_pk_bf16_f32 v60, v120, v121
    v_cvt_pk_bf16_f32 v61, v122, v123
    s_waitcnt lgkmcnt(8)
    v_mfma_f32_32x32x16_bf16 v[144:159], v[36:39], a[12:15], v[144:159]
    ds_read_b64_tr_b16 v[32:33], v22 offset:8192
    ds_read_b64_tr_b16 v[34:35], v22 offset:8448
    v_cvt_pk_bf16_f32 v62, v124, v125
    v_cvt_pk_bf16_f32 v63, v126, v127
    buffer_store_dwordx4 v[60:63], v100, s[16:19], s43 offen offset:3072 sc1
    s_waitcnt lgkmcnt(8)
    v_mfma_f32_32x32x16_bf16 v[144:159], v[40:43], a[16:19], v[144:159]
    ds_read_b64_tr_b16 v[36:37], v22 offset:9216
    ds_read_b64_tr_b16 v[38:39], v22 offset:9472
    v_cvt_pk_bf16_f32 v64, v128, v129
    v_cvt_pk_bf16_f32 v65, v130, v131
    v_cvt_pk_bf16_f32 v66, v132, v133
    s_waitcnt lgkmcnt(8)
    v_mfma_f32_32x32x16_bf16 v[144:159], v[44:47], a[20:23], v[144:159]
    ds_read_b64_tr_b16 v[40:41], v22 offset:10240
    ds_read_b64_tr_b16 v[42:43], v22 offset:10496
    v_cvt_pk_bf16_f32 v67, v134, v135
    buffer_store_dwordx4 v[64:67], v102, s[16:19], s43 offen offset:2048 sc1
    v_cvt_pk_bf16_f32 v68, v136, v137
    s_waitcnt lgkmcnt(8)
    v_mfma_f32_32x32x16_bf16 v[144:159], v[24:27], a[24:27], v[144:159]
    ds_read_b64_tr_b16 v[44:45], v22 offset:11264
    ds_read_b64_tr_b16 v[46:47], v22 offset:11520
    v_cvt_pk_bf16_f32 v69, v138, v139
    v_cvt_pk_bf16_f32 v70, v140, v141
    v_cvt_pk_bf16_f32 v71, v142, v143
    s_waitcnt lgkmcnt(8)
    v_mfma_f32_32x32x16_bf16 v[144:159], v[28:31], a[28:31], v[144:159]
    s_waitcnt vmcnt(7)
    s_barrier
    ds_read_b64_tr_b16 v[24:25], v22 offset:12288
    ds_read_b64_tr_b16 v[26:27], v22 offset:12544
    buffer_store_dwordx4 v[68:71], v102, s[16:19], s43 offen offset:3072 sc1
    s_waitcnt lgkmcnt(8)
    v_mfma_f32_32x32x16_bf16 v[144:159], v[32:35], a[32:35], v[144:159]
    ds_read_b64_tr_b16 v[28:29], v22 offset:13312
    ds_read_b64_tr_b16 v[30:31], v22 offset:13568
    s_waitcnt lgkmcnt(8)
    v_mfma_f32_32x32x16_bf16 v[144:159], v[36:39], a[36:39], v[144:159]
    ds_read_b64_tr_b16 v[32:33], v22 offset:14336
    ds_read_b64_tr_b16 v[34:35], v22 offset:14592
    s_waitcnt lgkmcnt(8)
    v_mfma_f32_32x32x16_bf16 v[144:159], v[40:43], a[40:43], v[144:159]
    ds_read_b64_tr_b16 v[36:37], v22 offset:15360
    ds_read_b64_tr_b16 v[38:39], v22 offset:15616
    s_waitcnt lgkmcnt(8)
    v_mfma_f32_32x32x16_bf16 v[144:159], v[44:47], a[44:47], v[144:159]
    ds_read_b64_tr_b16 v[40:41], v22 offset:16384
    ds_read_b64_tr_b16 v[42:43], v22 offset:16640
    s_waitcnt lgkmcnt(8)
    v_mfma_f32_32x32x16_bf16 v[144:159], v[24:27], a[48:51], v[144:159]
    ds_read_b64_tr_b16 v[44:45], v22 offset:17408
    ds_read_b64_tr_b16 v[46:47], v22 offset:17664
    s_waitcnt lgkmcnt(8)
    v_mfma_f32_32x32x16_bf16 v[144:159], v[28:31], a[52:55], v[144:159]
    ds_read_b64_tr_b16 v[24:25], v22 offset:18432
    ds_read_b64_tr_b16 v[26:27], v22 offset:18688
    s_waitcnt lgkmcnt(8)
    v_mfma_f32_32x32x16_bf16 v[144:159], v[32:35], a[56:59], v[144:159]
    ds_read_b64_tr_b16 v[28:29], v22 offset:19456
    ds_read_b64_tr_b16 v[30:31], v22 offset:19712
    s_waitcnt lgkmcnt(8)
    v_mfma_f32_32x32x16_bf16 v[144:159], v[36:39], a[60:63], v[144:159]
    ds_read_b64_tr_b16 v[32:33], v22 offset:20480
    ds_read_b64_tr_b16 v[34:35], v22 offset:20736
    s_waitcnt lgkmcnt(8)
    v_mfma_f32_32x32x16_bf16 v[144:159], v[40:43], a[64:67], v[144:159]
    ds_read_b64_tr_b16 v[36:37], v22 offset:21504
    ds_read_b64_tr_b16 v[38:39], v22 offset:21760
    s_waitcnt lgkmcnt(8)
    v_mfma_f32_32x32x16_bf16 v[144:159], v[44:47], a[68:71], v[144:159]
    ds_read_b64_tr_b16 v[40:41], v22 offset:22528
    ds_read_b64_tr_b16 v[42:43], v22 offset:22784
    s_waitcnt lgkmcnt(8)
    v_mfma_f32_32x32x16_bf16 v[144:159], v[24:27], a[72:75], v[144:159]
    ds_read_b64_tr_b16 v[44:45], v22 offset:23552
    ds_read_b64_tr_b16 v[46:47], v22 offset:23808
    s_waitcnt lgkmcnt(8)
    v_mfma_f32_32x32x16_bf16 v[144:159], v[28:31], a[76:79], v[144:159]
    s_waitcnt vmcnt(7)
    s_barrier
    ds_read_b64_tr_b16 v[24:25], v22 offset:24576
    ds_read_b64_tr_b16 v[26:27], v22 offset:24832
    s_waitcnt lgkmcnt(8)
    v_mfma_f32_32x32x16_bf16 v[144:159], v[32:35], a[80:83], v[144:159]
    ds_read_b64_tr_b16 v[28:29], v22 offset:25600
    ds_read_b64_tr_b16 v[30:31], v22 offset:25856
    s_waitcnt lgkmcnt(8)
    v_mfma_f32_32x32x16_bf16 v[144:159], v[36:39], a[84:87], v[144:159]
    ds_read_b64_tr_b16 v[32:33], v22 offset:26624
    ds_read_b64_tr_b16 v[34:35], v22 offset:26880
    s_waitcnt lgkmcnt(8)
    v_mfma_f32_32x32x16_bf16 v[144:159], v[40:43], a[88:91], v[144:159]
    ds_read_b64_tr_b16 v[36:37], v22 offset:27648
    ds_read_b64_tr_b16 v[38:39], v22 offset:27904
    s_waitcnt lgkmcnt(8)
    v_mfma_f32_32x32x16_bf16 v[144:159], v[44:47], a[92:95], v[144:159]
    s_waitcnt lgkmcnt(6)
    v_mfma_f32_32x32x16_bf16 v[144:159], v[24:27], a[96:99], v[144:159]
    s_waitcnt lgkmcnt(4)
    v_mfma_f32_32x32x16_bf16 v[144:159], v[28:31], a[100:103], v[144:159]
    s_waitcnt lgkmcnt(2)
    v_mfma_f32_32x32x16_bf16 v[144:159], v[32:35], a[104:107], v[144:159]
    s_waitcnt lgkmcnt(0)
    v_mfma_f32_32x32x16_bf16 v[144:159], v[36:39], a[108:111], v[144:159]
    s_nop 11
    v_pk_mul_f32 v[144:145], v[144:145], s[66:67]
    v_pk_mul_f32 v[146:147], v[146:147], s[66:67]
    v_pk_mul_f32 v[148:149], v[148:149], s[66:67]
    v_pk_mul_f32 v[150:151], v[150:151], s[66:67]
    v_cvt_pk_bf16_f32 v72, v144, v145
    v_cvt_pk_bf16_f32 v74, v148, v149
    v_cvt_pk_bf16_f32 v73, v146, v147
    v_cvt_pk_bf16_f32 v75, v150, v151
    v_permlane32_swap_b32 v72, v74
    s_cmp_lg_u64 s[54:55], 0
    v_permlane32_swap_b32 v73, v75
    s_cbranch_scc1 P1_VVQ_x20
P1_VVQ_e20:
    buffer_store_dwordx4 v[72:75], v104, s[16:19], s60 offen sc1
    v_pk_mul_f32 v[152:153], v[152:153], s[66:67]
    v_pk_mul_f32 v[154:155], v[154:155], s[66:67]
    v_pk_mul_f32 v[156:157], v[156:157], s[66:67]
    v_pk_mul_f32 v[158:159], v[158:159], s[66:67]
    v_cvt_pk_bf16_f32 v76, v152, v153
    v_cvt_pk_bf16_f32 v78, v156, v157
    v_cvt_pk_bf16_f32 v77, v154, v155
    v_cvt_pk_bf16_f32 v79, v158, v159
    v_permlane32_swap_b32 v76, v78
    s_cmp_lg_u64 s[56:57], 0
    v_permlane32_swap_b32 v77, v79
    s_cbranch_scc1 P1_VVQ_x21
P1_VVQ_e21:
    buffer_store_dwordx4 v[76:79], v105, s[16:19], s60 offen sc1
    s_branch P1_done
P1_VVQ_x20:
    s_mov_b64 exec, s[54:55]
    v_mov_b32 v96, v74
    v_mov_b32 v97, v75
    v_mov_b32 v74, v98
    v_mov_b32 v75, 0
    buffer_store_dwordx4 v[96:99], v104, s[16:19], s88 offen sc1
    s_mov_b64 exec, -1
    s_branch P1_VVQ_e20
P1_VVQ_x21:
    s_mov_b64 exec, s[56:57]
    v_mov_b32 v96, v78
    v_mov_b32 v97, v79
    v_mov_b32 v78, v98
    v_mov_b32 v79, 0
    buffer_store_dwordx4 v[96:99], v105, s[16:19], s88 offen sc1
    s_mov_b64 exec, -1
    s_branch P1_VVQ_e21
P1_VVV:
    s_add_u32 m0, s45, 0
    s_nop 0
    buffer_load_dwordx4 v13, s[12:15], s72 offen lds
    s_lshl_b32 s42, s27, 11
    s_add_u32 s42, s42, 1048576
    s_lshl_b32 s43, s27, 12
    s_add_u32 s43, s43, 3145728
    s_mul_i32 s38, s24, 3
    s_add_u32 s38, s38, s44
    s_lshl_b32 s3, s24, 4
    s_add_u32 s3, s3, s25
    s_lshl_b32 s3, s3, 7
    s_add_u32 s3, s3, 32768
    v_cmp_eq_u32 vcc, 0, v7
    v_mov_b32 v2, 0x3f803f80
    s_nop 0
    v_cndmask_b32 v92, 0, v2, vcc
    v_mov_b32 v93, v92
    v_mov_b32 v94, v92
    v_mov_b32 v95, v92
    s_add_u32 s39, s38, -28
    s_lshl_b32 s41, s39, 3
    v_add_u32 v2, s41, v6
    v_mul_u32_u24 v2, 147, v2
    v_lshrrev_b32 v2, 10, v2
    v_lshlrev_b32 v2, 18, v2
    v_bfe_u32 v3, v1, 2, 2
    v_lshl_add_u32 v2, v3, 9, v2
    v_lshl_add_u32 v2, v7, 4, v2
    v_add_u32 v101, 2496, v2
    s_lshl_b32 s39, s39, 5
    v_add_u32 v2, s39, v5
    v_mul_u32_u24 v3, 2341, v2
    v_lshrrev_b32 v3, 16, v3
    v_mul_u32_u24 v4, 28, v3
    v_sub_u32 v2, v2, v4
    v_lshlrev_b32 v3, 18, v3
    v_lshl_add_u32 v3, v2, 4, v3
    v_lshl_add_u32 v100, v6, 9, v3
    s_add_u32 s39, s38, -27
    s_lshl_b32 s41, s39, 3
    v_add_u32 v2, s41, v6
    v_mul_u32_u24 v2, 147, v2
    v_lshrrev_b32 v2, 10, v2
    v_lshlrev_b32 v2, 18, v2
    v_bfe_u32 v3, v1, 2, 2
    v_lshl_add_u32 v2, v3, 9, v2
    v_lshl_add_u32 v2, v7, 4, v2
    v_add_u32 v103, 2496, v2
    s_lshl_b32 s39, s39, 5
    v_add_u32 v2, s39, v5
    v_mul_u32_u24 v3, 2341, v2
    v_lshrrev_b32 v3, 16, v3
    v_mul_u32_u24 v4, 28, v3
    v_sub_u32 v2, v2, v4
    v_lshlrev_b32 v3, 18, v3
    v_lshl_add_u32 v3, v2, 4, v3
    v_lshl_add_u32 v102, v6, 9, v3
    s_mul_i32 s39, s44, 3
    s_sub_u32 s39, s38, s39
    s_add_u32 s39, s39, -26
    s_lshl_b32 s41, s39, 3
    v_add_u32 v2, s41, v6
    v_mul_u32_u24 v2, 147, v2
    v_lshrrev_b32 v2, 10, v2
    v_lshlrev_b32 v2, 18, v2
    v_bfe_u32 v3, v1, 2, 2
    v_lshl_add_u32 v2, v3, 9, v2
    v_lshl_add_u32 v2, v7, 4, v2
    v_add_u32 v105, 2496, v2
    s_lshl_b32 s39, s39, 5
    v_add_u32 v2, s39, v5
    v_mul_u32_u24 v3, 2341, v2
    v_lshrrev_b32 v3, 16, v3
    v_mul_u32_u24 v4, 28, v3
    v_sub_u32 v2, v2, v4
    v_lshlrev_b32 v3, 18, v3
    v_lshl_add_u32 v3, v2, 4, v3
    v_lshl_add_u32 v104, v6, 9, v3
    s_lshr_b32 s100, s2, 4
    s_lshl_b32 s100, s100, 2
    s_add_u32 s100, s100, s26
    s_lshl_b32 s100, s100, 3
    s_and_b32 s101, s2, 7
    s_add_u32 s100, s100, s101
    s_lshl_b32 s100, s100, 1
    s_and_b32 s101, s29, 1
    s_add_u32 s100, s100, s101
    s_lshl_b32 s101, s100, 11
    s_add_u32 s101, s101, 7340032
    v_lshrrev_b32 v2, 3, v0
    v_min_u32 v2, 1, v2
    v_lshlrev_b32 v3, 4, v1
    v_lshl_or_b32 v85, v2, 30, v3
    v_mov_b32 v80, -1
    v_mov_b32 v81, -1
    v_mov_b32 v82, -1
    v_mov_b32 v83, -1
    s_waitcnt lgkmcnt(0)
    s_mul_i32 s68, s68, 1664525
    s_add_u32 s68, s68, 1013904223
    s_mul_i32 s69, s69, 22695477
    s_add_u32 s69, s69, 1
    s_waitcnt vmcnt(7)
    s_barrier
    ds_read_b128 a[0:3], v16 offset:0
    ds_read_b64_tr_b16 v[24:25], v20 offset:0
    ds_read_b64_tr_b16 v[26:27], v20 offset:512
    ds_read_b64_tr_b16 v[28:29], v21 offset:0
    ds_read_b64_tr_b16 v[30:31], v21 offset:512
    ds_read_b128 a[4:7], v17 offset:0
    ds_read_b64_tr_b16 v[32:33], v20 offset:2048
    ds_read_b64_tr_b16 v[34:35], v20 offset:2560
    ds_read_b64_tr_b16 v[36:37], v21 offset:2048
    ds_read_b64_tr_b16 v[38:39], v21 offset:2560
    s_add_u32 m0, s36, 16384
    s_waitcnt lgkmcnt(7)
    v_mfma_f32_32x32x16_bf16 v[112:127], a[0:3], v[24:27], 0
    buffer_load_dwordx4 v12, s[12:15], s76 offen lds
    ds_read_b128 a[8:11], v18 offset:0
    ds_read_b64_tr_b16 v[40:41], v20 offset:4096
    ds_read_b64_tr_b16 v[42:43], v20 offset:4608
    s_add_u32 m0, s36, 17408
    s_waitcnt lgkmcnt(8)
    v_mfma_f32_32x32x16_bf16 v[128:143], a[0:3], v[28:31], 0
    buffer_load_dwordx4 v14, s[12:15], s76 offen lds
    ds_read_b64_tr_b16 v[44:45], v21 offset:4096
    ds_read_b64_tr_b16 v[46:47], v21 offset:4608
    s_add_u32 m0, s35, 8192
    s_waitcnt lgkmcnt(7)
    v_mfma_f32_32x32x16_bf16 v[112:127], a[4:7], v[32:35], v[112:127]
    buffer_load_dwordx4 v8, s[8:11], s77 offen lds
    ds_read_b128 a[12:15], v19 offset:0
    ds_read_b64_tr_b16 v[24:25], v20 offset:6144
    ds_read_b64_tr_b16 v[26:27], v20 offset:6656
    s_add_u32 m0, s35, 9216
    s_waitcnt lgkmcnt(8)
    v_mfma_f32_32x32x16_bf16 v[128:143], a[4:7], v[36:39], v[128:143]
    buffer_load_dwordx4 v9, s[8:11], s77 offen lds
    ds_read_b64_tr_b16 v[28:29], v21 offset:6144
    ds_read_b64_tr_b16 v[30:31], v21 offset:6656
    s_add_u32 m0, s35, 10240
    s_waitcnt lgkmcnt(7)
    v_mfma_f32_32x32x16_bf16 v[112:127], a[8:11], v[40:43], v[112:127]
    buffer_load_dwordx4 v10, s[8:11], s77 offen lds
    s_waitcnt vmcnt(6)
    s_barrier
    ds_read_b128 a[16:19], v16 offset:4096
    ds_read_b64_tr_b16 v[32:33], v20 offset:8192
    ds_read_b64_tr_b16 v[34:35], v20 offset:8704
    s_add_u32 m0, s35, 11264
    s_waitcnt lgkmcnt(8)
    v_mfma_f32_32x32x16_bf16 v[128:143], a[8:11], v[44:47], v[128:143]
    buffer_load_dwordx4 v11, s[8:11], s77 offen lds
    ds_read_b64_tr_b16 v[36:37], v21 offset:8192
    ds_read_b64_tr_b16 v[38:39], v21 offset:8704
    s_add_u32 m0, s36, 24576
    s_waitcnt lgkmcnt(7)
    v_mfma_f32_32x32x16_bf16 v[112:127], a[12:15], v[24:27], v[112:127]
    buffer_load_dwordx4 v12, s[12:15], s78 offen lds
    ds_read_b128 a[20:23], v17 offset:4096
    ds_read_b64_tr_b16 v[40:41], v20 offset:10240
    ds_read_b64_tr_b16 v[42:43], v20 offset:10752
    s_add_u32 m0, s36, 25600
    s_waitcnt lgkmcnt(8)
    v_mfma_f32_32x32x16_bf16 v[128:143], a[12:15], v[28:31], v[128:143]
    buffer_load_dwordx4 v14, s[12:15], s78 offen lds
    ds_read_b64_tr_b16 v[44:45], v21 offset:10240
    ds_read_b64_tr_b16 v[46:47], v21 offset:10752
    s_add_u32 m0, s35, 12288
    s_waitcnt lgkmcnt(7)
    v_mfma_f32_32x32x16_bf16 v[112:127], a[16:19], v[32:35], v[112:127]
    buffer_load_dwordx4 v8, s[8:11], s79 offen lds
    ds_read_b128 a[24:27], v18 offset:4096
    ds_read_b64_tr_b16 v[24:25], v20 offset:12288
    ds_read_b64_tr_b16 v[26:27], v20 offset:12800
    s_add_u32 m0, s35, 13312
    s_waitcnt lgkmcnt(8)
    v_mfma_f32_32x32x16_bf16 v[128:143], a[16:19], v[36:39], v[128:143]
    buffer_load_dwordx4 v9, s[8:11], s79 offen lds
    ds_read_b64_tr_b16 v[28:29], v21 offset:12288
    ds_read_b64_tr_b16 v[30:31], v21 offset:12800
    s_add_u32 m0, s35, 14336
    s_waitcnt lgkmcnt(7)
    v_mfma_f32_32x32x16_bf16 v[112:127], a[20:23], v[40:43], v[112:127]
    buffer_load_dwordx4 v10, s[8:11], s79 offen lds
    ds_read_b128 a[28:31], v19 offset:4096
    ds_read_b64_tr_b16 v[32:33], v20 offset:14336
    ds_read_b64_tr_b16 v[34:35], v20 offset:14848
    s_add_u32 m0, s35, 15360
    s_waitcnt lgkmcnt(8)
    v_mfma_f32_32x32x16_bf16 v[128:143], a[20:23], v[44:47], v[128:143]
    buffer_load_dwordx4 v11, s[8:11], s79 offen lds
    ds_read_b64_tr_b16 v[36:37], v21 offset:14336
    ds_read_b64_tr_b16 v[38:39], v21 offset:14848
    s_add_u32 m0, s36, 32768
    s_waitcnt lgkmcnt(7)
    v_mfma_f32_32x32x16_bf16 v[112:127], a[24:27], v[24:27], v[112:127]
    buffer_load_dwordx4 v12, s[12:15], s80 offen lds
    s_waitcnt vmcnt(7)
    s_barrier
    ds_read_b128 a[32:35], v16 offset:8192
    ds_read_b64_tr_b16 v[40:41], v20 offset:16384
    ds_read_b64_tr_b16 v[42:43], v20 offset:16896
    s_add_u32 m0, s36, 33792
    s_waitcnt lgkmcnt(8)
    v_mfma_f32_32x32x16_bf16 v[128:143], a[24:27], v[28:31], v[128:143]
    buffer_load_dwordx4 v14, s[12:15], s80 offen lds
    ds_read_b64_tr_b16 v[44:45], v21 offset:16384
    ds_read_b64_tr_b16 v[46:47], v21 offset:16896
    s_add_u32 m0, s35, 0
    s_waitcnt lgkmcnt(7)
    v_mfma_f32_32x32x16_bf16 v[112:127], a[28:31], v[32:35], v[112:127]
    buffer_load_dwordx4 v8, s[8:11], s81 offen lds
    ds_read_b128 a[36:39], v17 offset:8192
    ds_read_b64_tr_b16 v[24:25], v20 offset:18432
    ds_read_b64_tr_b16 v[26:27], v20 offset:18944
    s_add_u32 m0, s35, 1024
    s_waitcnt lgkmcnt(8)
    v_mfma_f32_32x32x16_bf16 v[128:143], a[28:31], v[36:39], v[128:143]
    buffer_load_dwordx4 v9, s[8:11], s81 offen lds
    ds_read_b64_tr_b16 v[28:29], v21 offset:18432
    ds_read_b64_tr_b16 v[30:31], v21 offset:18944
    s_add_u32 m0, s35, 2048
    s_waitcnt lgkmcnt(7)
    v_mfma_f32_32x32x16_bf16 v[112:127], a[32:35], v[40:43], v[112:127]
    buffer_load_dwordx4 v10, s[8:11], s81 offen lds
    ds_read_b128 a[40:43], v18 offset:8192
    ds_read_b64_tr_b16 v[32:33], v20 offset:20480
    ds_read_b64_tr_b16 v[34:35], v20 offset:20992
    s_add_u32 m0, s35, 3072
    s_waitcnt lgkmcnt(8)
    v_mfma_f32_32x32x16_bf16 v[128:143], a[32:35], v[44:47], v[128:143]
    buffer_load_dwordx4 v11, s[8:11], s81 offen lds
    ds_read_b64_tr_b16 v[36:37], v21 offset:20480
    ds_read_b64_tr_b16 v[38:39], v21 offset:20992
    s_add_u32 m0, s36, 40960
    s_waitcnt lgkmcnt(7)
    v_mfma_f32_32x32x16_bf16 v[112:127], a[36:39], v[24:27], v[112:127]
    buffer_load_dwordx4 v12, s[12:15], s82 offen lds
    ds_read_b128 a[44:47], v19 offset:8192
    ds_read_b64_tr_b16 v[40:41], v20 offset:22528
    ds_read_b64_tr_b16 v[42:43], v20 offset:23040
    s_add_u32 m0, s36, 41984
    s_waitcnt lgkmcnt(8)
    v_mfma_f32_32x32x16_bf16 v[128:143], a[36:39], v[28:31], v[128:143]
    buffer_load_dwordx4 v14, s[12:15], s82 offen lds
    ds_read_b64_tr_b16 v[44:45], v21 offset:22528
    ds_read_b64_tr_b16 v[46:47], v21 offset:23040
    s_add_u32 m0, s35, 4096
    s_waitcnt lgkmcnt(7)
    v_mfma_f32_32x32x16_bf16 v[112:127], a[40:43], v[32:35], v[112:127]
    buffer_load_dwordx4 v8, s[8:11], s83 offen lds
    s_waitcnt vmcnt(9)
    s_barrier
    ds_read_b128 a[48:51], v16 offset:12288
    ds_read_b64_tr_b16 v[24:25], v20 offset:24576
    ds_read_b64_tr_b16 v[26:27], v20 offset:25088
    s_add_u32 m0, s35, 5120
    s_waitcnt lgkmcnt(8)
    v_mfma_f32_32x32x16_bf16 v[128:143], a[40:43], v[36:39], v[128:143]
    buffer_load_dwordx4 v9, s[8:11], s83 offen lds
    ds_read_b64_tr_b16 v[28:29], v21 offset:24576
    ds_read_b64_tr_b16 v[30:31], v21 offset:25088
    s_add_u32 m0, s35, 6144
    s_waitcnt lgkmcnt(7)
    v_mfma_f32_32x32x16_bf16 v[112:127], a[44:47], v[40:43], v[112:127]
    buffer_load_dwordx4 v10, s[8:11], s83 offen lds
    ds_read_b128 a[52:55], v17 offset:12288
    ds_read_b64_tr_b16 v[32:33], v20 offset:26624
    ds_read_b64_tr_b16 v[34:35], v20 offset:27136
    s_add_u32 m0, s35, 7168
    s_waitcnt lgkmcnt(8)
    v_mfma_f32_32x32x16_bf16 v[128:143], a[44:47], v[44:47], v[128:143]
    buffer_load_dwordx4 v11, s[8:11], s83 offen lds
    ds_read_b64_tr_b16 v[36:37], v21 offset:26624
    ds_read_b64_tr_b16 v[38:39], v21 offset:27136
    s_add_u32 m0, s36, 49152
    s_waitcnt lgkmcnt(7)
    v_mfma_f32_32x32x16_bf16 v[112:127], a[48:51], v[24:27], v[112:127]
    buffer_load_dwordx4 v12, s[12:15], s84 offen lds
    ds_read_b128 a[56:59], v18 offset:12288
    ds_read_b64_tr_b16 v[40:41], v20 offset:28672
    ds_read_b64_tr_b16 v[42:43], v20 offset:29184
    s_add_u32 m0, s36, 50176
    s_waitcnt lgkmcnt(8)
    v_mfma_f32_32x32x16_bf16 v[128:143], a[48:51], v[28:31], v[128:143]
    buffer_load_dwordx4 v14, s[12:15], s84 offen lds
    ds_read_b64_tr_b16 v[44:45], v21 offset:28672
    ds_read_b64_tr_b16 v[46:47], v21 offset:29184
    s_add_u32 m0, s35, 8192
    s_waitcnt lgkmcnt(7)
    v_mfma_f32_32x32x16_bf16 v[112:127], a[52:55], v[32:35], v[112:127]
    buffer_load_dwordx4 v8, s[8:11], s85 offen lds
    ds_read_b128 a[60:63], v19 offset:12288
    ds_read_b64_tr_b16 v[24:25], v20 offset:30720
    ds_read_b64_tr_b16 v[26:27], v20 offset:31232
    s_add_u32 m0, s35, 9216
    s_waitcnt lgkmcnt(8)
    v_mfma_f32_32x32x16_bf16 v[128:143], a[52:55], v[36:39], v[128:143]
    buffer_load_dwordx4 v9, s[8:11], s85 offen lds
    ds_read_b64_tr_b16 v[28:29], v21 offset:30720
    ds_read_b64_tr_b16 v[30:31], v21 offset:31232
    s_add_u32 m0, s35, 10240
    s_waitcnt lgkmcnt(7)
    v_mfma_f32_32x32x16_bf16 v[112:127], a[56:59], v[40:43], v[112:127]
    buffer_load_dwordx4 v10, s[8:11], s85 offen lds
    s_waitcnt vmcnt(11)
    s_barrier
    ds_read_b128 a[64:67], v16 offset:0
    ds_read_b64_tr_b16 v[32:33], v20 offset:32768
    ds_read_b64_tr_b16 v[34:35], v20 offset:33280
    s_add_u32 m0, s35, 11264
    s_waitcnt lgkmcnt(8)
    v_mfma_f32_32x32x16_bf16 v[128:143], a[56:59], v[44:47], v[128:143]
    buffer_load_dwordx4 v11, s[8:11], s85 offen lds
    ds_read_b64_tr_b16 v[36:37], v21 offset:32768
    ds_read_b64_tr_b16 v[38:39], v21 offset:33280
    s_add_u32 m0, s45, 4096
    s_waitcnt lgkmcnt(7)
    v_mfma_f32_32x32x16_bf16 v[112:127], a[60:63], v[24:27], v[112:127]
    buffer_load_dwordx4 v13, s[12:15], s74 offen lds
    ds_read_b128 a[68:71], v17 offset:0
    ds_read_b64_tr_b16 v[40:41], v20 offset:34816
    ds_read_b64_tr_b16 v[42:43], v20 offset:35328
    s_add_u32 m0, s45, 8192
    s_waitcnt lgkmcnt(8)
    v_mfma_f32_32x32x16_bf16 v[128:143], a[60:63], v[28:31], v[128:143]
    buffer_load_dwordx4 v13, s[12:15], s76 offen lds
    ds_read_b64_tr_b16 v[44:45], v21 offset:34816
    ds_read_b64_tr_b16 v[46:47], v21 offset:35328
    s_add_u32 m0, s45, 12288
    s_waitcnt lgkmcnt(7)
    v_mfma_f32_32x32x16_bf16 v[112:127], a[64:67], v[32:35], v[112:127]
    buffer_load_dwordx4 v13, s[12:15], s78 offen lds
    ds_read_b128 a[72:75], v18 offset:0
    ds_read_b64_tr_b16 v[24:25], v20 offset:36864
    ds_read_b64_tr_b16 v[26:27], v20 offset:37376
    s_add_u32 m0, s45, 16384
    s_waitcnt lgkmcnt(8)
    v_mfma_f32_32x32x16_bf16 v[128:143], a[64:67], v[36:39], v[128:143]
    buffer_load_dwordx4 v13, s[12:15], s80 offen lds
    ds_read_b64_tr_b16 v[28:29], v21 offset:36864
    ds_read_b64_tr_b16 v[30:31], v21 offset:37376
    s_add_u32 m0, s45, 20480
    s_waitcnt lgkmcnt(7)
    v_mfma_f32_32x32x16_bf16 v[112:127], a[68:71], v[40:43], v[112:127]
    buffer_load_dwordx4 v13, s[12:15], s82 offen lds
    ds_read_b128 a[76:79], v19 offset:0
    ds_read_b64_tr_b16 v[32:33], v20 offset:38912
    ds_read_b64_tr_b16 v[34:35], v20 offset:39424
    s_add_u32 m0, s45, 24576
    s_waitcnt lgkmcnt(8)
    v_mfma_f32_32x32x16_bf16 v[128:143], a[68:71], v[44:47], v[128:143]
    buffer_load_dwordx4 v13, s[12:15], s84 offen lds
    ds_read_b64_tr_b16 v[36:37], v21 offset:38912
    ds_read_b64_tr_b16 v[38:39], v21 offset:39424
    s_waitcnt lgkmcnt(7)
    v_mfma_f32_32x32x16_bf16 v[112:127], a[72:75], v[24:27], v[112:127]
    s_waitcnt vmcnt(12)
    s_barrier
    ds_read_b128 a[80:83], v16 offset:4096
    ds_read_b64_tr_b16 v[40:41], v20 offset:40960
    ds_read_b64_tr_b16 v[42:43], v20 offset:41472
    buffer_store_dwordx4 v[80:83], v85, s[16:19], s3 offen sc1
    s_waitcnt lgkmcnt(8)
    v_mfma_f32_32x32x16_bf16 v[128:143], a[72:75], v[28:31], v[128:143]
    ds_read_b64_tr_b16 v[44:45], v21 offset:40960
    ds_read_b64_tr_b16 v[46:47], v21 offset:41472
    s_waitcnt lgkmcnt(7)
    v_mfma_f32_32x32x16_bf16 v[112:127], a[76:79], v[32:35], v[112:127]
    ds_read_b128 a[84:87], v17 offset:4096
    ds_read_b64_tr_b16 v[24:25], v20 offset:43008
    ds_read_b64_tr_b16 v[26:27], v20 offset:43520
    s_waitcnt lgkmcnt(8)
    v_mfma_f32_32x32x16_bf16 v[128:143], a[76:79], v[36:39], v[128:143]
    ds_read_b64_tr_b16 v[28:29], v21 offset:43008
    ds_read_b64_tr_b16 v[30:31], v21 offset:43520
    s_waitcnt lgkmcnt(7)
    v_mfma_f32_32x32x16_bf16 v[112:127], a[80:83], v[40:43], v[112:127]
    ds_read_b128 a[88:91], v18 offset:4096
    ds_read_b64_tr_b16 v[32:33], v20 offset:45056
    ds_read_b64_tr_b16 v[34:35], v20 offset:45568
    s_waitcnt lgkmcnt(8)
    v_mfma_f32_32x32x16_bf16 v[128:143], a[80:83], v[44:47], v[128:143]
    ds_read_b64_tr_b16 v[36:37], v21 offset:45056
    ds_read_b64_tr_b16 v[38:39], v21 offset:45568
    s_waitcnt lgkmcnt(7)
    v_mfma_f32_32x32x16_bf16 v[112:127], a[84:87], v[24:27], v[112:127]
    ds_read_b128 a[92:95], v19 offset:4096
    ds_read_b64_tr_b16 v[40:41], v20 offset:47104
    ds_read_b64_tr_b16 v[42:43], v20 offset:47616
    s_waitcnt lgkmcnt(8)
    v_mfma_f32_32x32x16_bf16 v[128:143], a[84:87], v[28:31], v[128:143]
    ds_read_b64_tr_b16 v[44:45], v21 offset:47104
    ds_read_b64_tr_b16 v[46:47], v21 offset:47616
    s_waitcnt lgkmcnt(7)
    v_mfma_f32_32x32x16_bf16 v[112:127], a[88:91], v[32:35], v[112:127]
    s_waitcnt vmcnt(7)
    s_barrier
    ds_read_b128 a[96:99], v16 offset:8192
    ds_read_b64_tr_b16 v[24:25], v20 offset:49152
    ds_read_b64_tr_b16 v[26:27], v20 offset:49664
    s_waitcnt lgkmcnt(8)
    v_mfma_f32_32x32x16_bf16 v[128:143], a[88:91], v[36:39], v[128:143]
    ds_read_b64_tr_b16 v[28:29], v21 offset:49152
    ds_read_b64_tr_b16 v[30:31], v21 offset:49664
    s_waitcnt lgkmcnt(7)
    v_mfma_f32_32x32x16_bf16 v[112:127], a[92:95], v[40:43], v[112:127]
    ds_read_b128 a[100:103], v17 offset:8192
    ds_read_b64_tr_b16 v[32:33], v20 offset:51200
    ds_read_b64_tr_b16 v[34:35], v20 offset:51712
    s_waitcnt lgkmcnt(8)
    v_mfma_f32_32x32x16_bf16 v[128:143], a[92:95], v[44:47], v[128:143]
    ds_read_b64_tr_b16 v[36:37], v21 offset:51200
    ds_read_b64_tr_b16 v[38:39], v21 offset:51712
    s_waitcnt lgkmcnt(7)
    v_mfma_f32_32x32x16_bf16 v[112:127], a[96:99], v[24:27], v[112:127]
    ds_read_b128 a[104:107], v18 offset:8192
    ds_read_b64_tr_b16 v[40:41], v20 offset:53248
    ds_read_b64_tr_b16 v[42:43], v20 offset:53760
    s_waitcnt lgkmcnt(8)
    v_mfma_f32_32x32x16_bf16 v[128:143], a[96:99], v[28:31], v[128:143]
    ds_read_b64_tr_b16 v[44:45], v21 offset:53248
    ds_read_b64_tr_b16 v[46:47], v21 offset:53760
    s_waitcnt lgkmcnt(7)
    v_mfma_f32_32x32x16_bf16 v[112:127], a[100:103], v[32:35], v[112:127]
    ds_read_b128 a[108:111], v19 offset:8192
    ds_read_b64_tr_b16 v[24:25], v20 offset:55296
    ds_read_b64_tr_b16 v[26:27], v20 offset:55808
    s_waitcnt lgkmcnt(8)
    v_mfma_f32_32x32x16_bf16 v[128:143], a[100:103], v[36:39], v[128:143]
    ds_read_b64_tr_b16 v[28:29], v21 offset:55296
    ds_read_b64_tr_b16 v[30:31], v21 offset:55808
    s_waitcnt lgkmcnt(7)
    v_mfma_f32_32x32x16_bf16 v[112:127], a[104:107], v[40:43], v[112:127]
    s_waitcnt lgkmcnt(5)
    v_mfma_f32_32x32x16_bf16 v[128:143], a[104:107], v[44:47], v[128:143]
    s_waitcnt lgkmcnt(2)
    v_mfma_f32_32x32x16_bf16 v[112:127], a[108:111], v[24:27], v[112:127]
    s_waitcnt lgkmcnt(0)
    v_mfma_f32_32x32x16_bf16 v[128:143], a[108:111], v[28:31], v[128:143]
    s_waitcnt vmcnt(5)
    s_barrier
    ds_read_b64_tr_b16 v[24:25], v22 offset:0
    ds_read_b64_tr_b16 v[26:27], v22 offset:256
    ds_read_b64_tr_b16 v[28:29], v22 offset:1024
    ds_read_b64_tr_b16 v[30:31], v22 offset:1280
    ds_read_b64_tr_b16 v[32:33], v22 offset:2048
    ds_read_b64_tr_b16 v[34:35], v22 offset:2304
    ds_read_b64_tr_b16 v[36:37], v22 offset:3072
    ds_read_b64_tr_b16 v[38:39], v22 offset:3328
    ds_read_b64_tr_b16 v[40:41], v22 offset:4096
    ds_read_b64_tr_b16 v[42:43], v22 offset:4352
    s_waitcnt lgkmcnt(8)
    v_mfma_f32_32x32x16_bf16 v[144:159], a[0:3], v[24:27], 0
    ds_read_b64_tr_b16 v[44:45], v22 offset:5120
    ds_read_b64_tr_b16 v[46:47], v22 offset:5376
    buffer_store_dwordx4 v[92:95], v101, s[16:19], s43 offen sc1
    buffer_store_dwordx4 v[92:95], v103, s[16:19], s43 offen sc1
    buffer_store_dwordx4 v[92:95], v105, s[16:19], s43 offen sc1
    s_waitcnt lgkmcnt(8)
    v_mfma_f32_32x32x16_bf16 v[144:159], a[4:7], v[28:31], v[144:159]
    ds_read_b64_tr_b16 v[24:25], v22 offset:6144
    ds_read_b64_tr_b16 v[26:27], v22 offset:6400
    v_cvt_pk_bf16_f32 v56, v112, v113
    v_cvt_pk_bf16_f32 v57, v114, v115
    v_cvt_pk_bf16_f32 v58, v116, v117
    s_waitcnt lgkmcnt(8)
    v_mfma_f32_32x32x16_bf16 v[144:159], a[8:11], v[32:35], v[144:159]
    ds_read_b64_tr_b16 v[28:29], v22 offset:7168
    ds_read_b64_tr_b16 v[30:31], v22 offset:7424
    v_cvt_pk_bf16_f32 v59, v118, v119
    buffer_store_dwordx4 v[56:59], v100, s[16:19], s43 offen offset:2048 sc1
    v_cvt_pk_bf16_f32 v60, v120, v121
    s_waitcnt lgkmcnt(8)
    v_mfma_f32_32x32x16_bf16 v[144:159], a[12:15], v[36:39], v[144:159]
    ds_read_b64_tr_b16 v[32:33], v22 offset:8192
    ds_read_b64_tr_b16 v[34:35], v22 offset:8448
    v_cvt_pk_bf16_f32 v61, v122, v123
    v_cvt_pk_bf16_f32 v62, v124, v125
    v_cvt_pk_bf16_f32 v63, v126, v127
    s_waitcnt lgkmcnt(8)
    v_mfma_f32_32x32x16_bf16 v[144:159], a[16:19], v[40:43], v[144:159]
    ds_read_b64_tr_b16 v[36:37], v22 offset:9216
    ds_read_b64_tr_b16 v[38:39], v22 offset:9472
    buffer_store_dwordx4 v[60:63], v100, s[16:19], s43 offen offset:3072 sc1
    v_cvt_pk_bf16_f32 v64, v128, v129
    v_cvt_pk_bf16_f32 v65, v130, v131
    s_waitcnt lgkmcnt(8)
    v_mfma_f32_32x32x16_bf16 v[144:159], a[20:23], v[44:47], v[144:159]
    ds_read_b64_tr_b16 v[40:41], v22 offset:10240
    ds_read_b64_tr_b16 v[42:43], v22 offset:10496
    v_cvt_pk_bf16_f32 v66, v132, v133
    v_cvt_pk_bf16_f32 v67, v134, v135
    buffer_store_dwordx4 v[64:67], v102, s[16:19], s43 offen offset:2048 sc1
    s_waitcnt lgkmcnt(8)
    v_mfma_f32_32x32x16_bf16 v[144:159], a[24:27], v[24:27], v[144:159]
    ds_read_b64_tr_b16 v[44:45], v22 offset:11264
    ds_read_b64_tr_b16 v[46:47], v22 offset:11520
    v_cvt_pk_bf16_f32 v68, v136, v137
    v_cvt_pk_bf16_f32 v69, v138, v139
    v_cvt_pk_bf16_f32 v70, v140, v141
    s_waitcnt lgkmcnt(8)
    v_mfma_f32_32x32x16_bf16 v[144:159], a[28:31], v[28:31], v[144:159]
    s_waitcnt vmcnt(8)
    s_barrier
    ds_read_b64_tr_b16 v[24:25], v22 offset:12288
    ds_read_b64_tr_b16 v[26:27], v22 offset:12544
    v_cvt_pk_bf16_f32 v71, v142, v143
    buffer_store_dwordx4 v[68:71], v102, s[16:19], s43 offen offset:3072 sc1
    s_waitcnt lgkmcnt(8)
    v_mfma_f32_32x32x16_bf16 v[144:159], a[32:35], v[32:35], v[144:159]
    ds_read_b64_tr_b16 v[28:29], v22 offset:13312
    ds_read_b64_tr_b16 v[30:31], v22 offset:13568
    s_waitcnt lgkmcnt(8)
    v_mfma_f32_32x32x16_bf16 v[144:159], a[36:39], v[36:39], v[144:159]
    ds_read_b64_tr_b16 v[32:33], v22 offset:14336
    ds_read_b64_tr_b16 v[34:35], v22 offset:14592
    s_waitcnt lgkmcnt(8)
    v_mfma_f32_32x32x16_bf16 v[144:159], a[40:43], v[40:43], v[144:159]
    ds_read_b64_tr_b16 v[36:37], v22 offset:15360
    ds_read_b64_tr_b16 v[38:39], v22 offset:15616
    s_waitcnt lgkmcnt(8)
    v_mfma_f32_32x32x16_bf16 v[144:159], a[44:47], v[44:47], v[144:159]
    ds_read_b64_tr_b16 v[40:41], v22 offset:16384
    ds_read_b64_tr_b16 v[42:43], v22 offset:16640
    s_waitcnt lgkmcnt(8)
    v_mfma_f32_32x32x16_bf16 v[144:159], a[48:51], v[24:27], v[144:159]
    ds_read_b64_tr_b16 v[44:45], v22 offset:17408
    ds_read_b64_tr_b16 v[46:47], v22 offset:17664
    s_waitcnt lgkmcnt(8)
    v_mfma_f32_32x32x16_bf16 v[144:159], a[52:55], v[28:31], v[144:159]
    ds_read_b64_tr_b16 v[24:25], v22 offset:18432
    ds_read_b64_tr_b16 v[26:27], v22 offset:18688
    s_waitcnt lgkmcnt(8)
    v_mfma_f32_32x32x16_bf16 v[144:159], a[56:59], v[32:35], v[144:159]
    ds_read_b64_tr_b16 v[28:29], v22 offset:19456
    ds_read_b64_tr_b16 v[30:31], v22 offset:19712
    s_waitcnt lgkmcnt(8)
    v_mfma_f32_32x32x16_bf16 v[144:159], a[60:63], v[36:39], v[144:159]
    ds_read_b64_tr_b16 v[32:33], v22 offset:20480
    ds_read_b64_tr_b16 v[34:35], v22 offset:20736
    s_waitcnt lgkmcnt(8)
    v_mfma_f32_32x32x16_bf16 v[144:159], a[64:67], v[40:43], v[144:159]
    ds_read_b64_tr_b16 v[36:37], v22 offset:21504
    ds_read_b64_tr_b16 v[38:39], v22 offset:21760
    s_waitcnt lgkmcnt(8)
    v_mfma_f32_32x32x16_bf16 v[144:159], a[68:71], v[44:47], v[144:159]
    ds_read_b64_tr_b16 v[40:41], v22 offset:22528
    ds_read_b64_tr_b16 v[42:43], v22 offset:22784
    s_waitcnt lgkmcnt(8)
    v_mfma_f32_32x32x16_bf16 v[144:159], a[72:75], v[24:27], v[144:159]
    ds_read_b64_tr_b16 v[44:45], v22 offset:23552
    ds_read_b64_tr_b16 v[46:47], v22 offset:23808
    s_waitcnt lgkmcnt(8)
    v_mfma_f32_32x32x16_bf16 v[144:159], a[76:79], v[28:31], v[144:159]
    s_waitcnt vmcnt(8)
    s_barrier
    ds_read_b64_tr_b16 v[24:25], v22 offset:24576
    ds_read_b64_tr_b16 v[26:27], v22 offset:24832
    s_waitcnt lgkmcnt(8)
    v_mfma_f32_32x32x16_bf16 v[144:159], a[80:83], v[32:35], v[144:159]
    ds_read_b64_tr_b16 v[28:29], v22 offset:25600
    ds_read_b64_tr_b16 v[30:31], v22 offset:25856
    s_waitcnt lgkmcnt(8)
    v_mfma_f32_32x32x16_bf16 v[144:159], a[84:87], v[36:39], v[144:159]
    ds_read_b64_tr_b16 v[32:33], v22 offset:26624
    ds_read_b64_tr_b16 v[34:35], v22 offset:26880
    s_waitcnt lgkmcnt(8)
    v_mfma_f32_32x32x16_bf16 v[144:159], a[88:91], v[40:43], v[144:159]
    ds_read_b64_tr_b16 v[36:37], v22 offset:27648
    ds_read_b64_tr_b16 v[38:39], v22 offset:27904
    s_waitcnt lgkmcnt(8)
    v_mfma_f32_32x32x16_bf16 v[144:159], a[92:95], v[44:47], v[144:159]
    s_waitcnt lgkmcnt(6)
    v_mfma_f32_32x32x16_bf16 v[144:159], a[96:99], v[24:27], v[144:159]
    s_waitcnt lgkmcnt(4)
    v_mfma_f32_32x32x16_bf16 v[144:159], a[100:103], v[28:31], v[144:159]
    s_waitcnt lgkmcnt(2)
    v_mfma_f32_32x32x16_bf16 v[144:159], a[104:107], v[32:35], v[144:159]
    s_waitcnt lgkmcnt(0)
    v_mfma_f32_32x32x16_bf16 v[144:159], a[108:111], v[36:39], v[144:159]
    s_nop 11
    v_cvt_pk_bf16_f32 v72, v144, v145
    v_cvt_pk_bf16_f32 v73, v146, v147
    v_cvt_pk_bf16_f32 v74, v148, v149
    v_cvt_pk_bf16_f32 v75, v150, v151
    buffer_store_dwordx4 v[72:75], v104, s[16:19], s43 offen offset:2048 sc1
    v_cvt_pk_bf16_f32 v76, v152, v153
    v_cvt_pk_bf16_f32 v77, v154, v155
    v_cvt_pk_bf16_f32 v78, v156, v157
    v_cvt_pk_bf16_f32 v79, v158, v159
    buffer_store_dwordx4 v[76:79], v104, s[16:19], s43 offen offset:3072 sc1
P1_done:
    v_cmp_gt_u32 vcc, 16, v1
    v_lshrrev_b32 v2, 3, v1
    v_add_u32 v2, 1, v2
    v_bfe_u32 v3, v1, 1, 1
    v_cndmask_b32 v2, v3, v2, vcc
    v_bfe_u32 v3, v1, 2, 1
    v_and_b32 v4, 1, v1
    v_cndmask_b32 v3, v4, v3, vcc
    v_mul_u32_u24 v2, 448, v2
    v_mul_u32_u24 v3, 27, v3
    s_and_b32 s37, s100, 15
    s_mul_i32 s37, s37, 28
    v_add3_u32 v2, v2, v3, s37
    v_mul_u32_u24 v2, 683, v2
    v_lshrrev_b32 v2, 16, v2
    v_and_b32 v213, 3, v1
    s_lshl_b32 s37, s26, 2
    v_add_u32 v3, s37, v213
    s_lshr_b32 s37, s2, 4
    v_mov_b32 v4, s37
    v_cndmask_b32 v3, v4, v3, vcc
    v_lshl_add_u32 v2, v2, 4, v3
    v_lshlrev_b32 v238, 7, v2
    v_lshlrev_b32 v240, 4, v1
    s_add_u32 s39, s26, 1
    s_and_b32 s39, s39, 3
    s_mul_i32 s39, s39, 12288
    s_add_u32 s39, s39, 8192
    v_add_u32 v230, s39, v240
    s_add_u32 s39, s26, 2
    s_and_b32 s39, s39, 3
    s_mul_i32 s39, s39, 12288
    s_add_u32 s39, s39, 4096
    v_add_u32 v231, s39, v240
    s_add_u32 s39, s26, 3
    s_and_b32 s39, s39, 3
    s_mul_i32 s39, s39, 12288
    v_add_u32 v232, s39, v240
    s_add_u32 s39, s26, 4
    s_and_b32 s39, s39, 3
    s_mul_i32 s39, s39, 12288
    v_add_u32 v233, s39, v240
    v_add_u32 v241, 4096, v240
    v_add_u32 v242, 8192, v240
    v_add_u32 v243, 12288, v240
    v_mov_b32 v229, 0xdddddddd
    v_and_b32 v3, 0x33, v1
    v_bfe_u32 v2, v1, 2, 1
    v_lshl_or_b32 v3, v2, 3, v3
    v_bfe_u32 v2, v1, 3, 1
    v_lshl_or_b32 v3, v2, 2, v3
    v_lshlrev_b32 v234, 4, v3
    v_lshlrev_b32 v228, 7, v1
    v_lshrrev_b32 v212, 5, v1
    v_lshrrev_b32 v211, 2, v1
    v_sub_u32 v2, 1, v212
    v_cvt_f32_u32 v235, v2
    v_mul_u32_u24 v4, 3584, v211
    v_lshl_add_u32 v4, v213, 7, v4
    v_mov_b32 v227, 0x7fffffff
    v_mov_b32 v222, 0x7fffffff
    v_mov_b32 v223, 0x7fffffff
    s_mov_b64 exec, 4095
    v_mov_b32 v227, v228
    s_cmp_ge_u32 s29, 24
    s_cselect_b32 exec_lo, 4095, 0
    v_mov_b32 v227, v4
    s_mov_b64 exec, 0xff
    v_mov_b32 v223, v228
    s_mov_b64 exec, 1
    v_mov_b32 v222, 0
    s_mov_b64 exec, -1
    v_and_b32 v2, 7, v1
    v_lshlrev_b32 v225, 3, v2
    v_mov_b32 v220, s68
    v_mov_b32 v221, s69
    v_mov_b32 v80, s68
    v_mov_b32 v81, s69
    s_cmp_lg_u32 s26, 0
    s_waitcnt vmcnt(0)
    s_barrier
    s_cbranch_scc1 P1_nf
    buffer_store_dwordx4 v[80:83], v85, s[16:19], s3 offen sc1
P1_nf:
    v_mov_b32 v220, s68
    v_mov_b32 v221, s69
    s_and_b32 s24, s100, 15
    s_lshr_b32 s25, s2, 4
    s_lshl_b32 s35, s24, 18
    s_add_u32 s35, s35, 3145728
    s_lshl_b32 s34, s26, 16
    s_add_u32 s34, s34, s35
    s_lshl_b32 s36, s24, 17
    s_lshl_b32 s37, s25, 13
    s_add_u32 s36, s36, s37
    s_add_u32 s36, s36, 1048576
    s_lshl_b32 s37, s26, 11
    s_add_u32 s47, s36, s37
    s_lshl_b32 s38, s29, 2
    s_add_u32 s38, s38, s26
    s_and_b32 s42, s2, 7
    s_mul_i32 s56, s38, 9216
    s_movk_i32 s57, 1536
    s_mov_b64 s[52:53], s[20:21]
    s_mov_b32 s54, 401408
    s_mov_b32 s55, 0x20000
    s_cmp_lt_u32 s38, 64
    s_cbranch_scc1 P1_pf
    s_mul_i32 s39, s42, 229376
    s_add_u32 s56, s56, s39
    s_sub_u32 s56, s56, 589824
    s_mov_b64 s[52:53], s[98:99]
    s_cmp_lt_u32 s38, 89
    s_cselect_b32 s54, 1605632, 0
    s_cmp_lt_u32 s38, 96
    s_cbranch_scc1 P1_pf
    s_sub_u32 s38, s38, 96
    s_mul_i32 s56, s38, 64512
    s_lshl_b32 s39, s42, 9
    s_add_u32 s56, s56, s39
    s_movk_i32 s57, 10752
    s_mov_b64 s[52:53], s[96:97]
    s_cmp_lt_u32 s42, 7
    s_cselect_b32 s54, 1605632, 0
P1_pf:
    s_movk_i32 s63, 0x207
    s_mov_b32 s66, 0x61800000
    s_mov_b32 s67, s66
    s_lshl_b32 s60, s100, 7
    s_add_u32 s61, s60, 9437184
    s_add_u32 s60, s60, 65536
    s_and_b32 s27, s26, 1
    s_lshr_b32 s28, s26, 1
    s_lshl_b32 s30, s71, 1
    s_add_u32 s30, s30, s27
    s_lshl_b32 s59, s30, 1
    s_add_u32 s59, s59, s28
    s_lshl_b32 s36, s59, 14
    s_add_u32 s36, s36, 7340032
    s_lshl_b32 s59, s59, 10
    s_add_u32 s58, s59, 9437184
    s_lshl_b32 s38, s30, 5
    v_add_u32 v2, s38, v211
    v_mul_u32_u24 v224, 896, v2
    v_lshl_add_u32 v224, v213, 4, v224
    v_lshlrev_b32 v237, 3, v2
    s_lshl_b32 s31, s70, 7
    s_lshl_b32 s38, s28, 6
    s_add_u32 s31, s31, s38
    s_add_u32 s89, s31, 14336
    s_movk_i32 s91, 16384
    s_mov_b64 s[4:5], s[20:21]
    s_mov_b32 s6, 401408
    s_mov_b32 s7, 0x20000
    s_mov_b32 s95, 99
    s_mov_b64 s[12:13], s[92:93]
    s_mov_b32 s14, 1835008
    buffer_load_dwordx4 v[176:179], v224, s[8:11], s31 offen
    buffer_load_dwordx4 v[180:183], v224, s[8:11], s89 offen
    buffer_load_dwordx2 v[8:9], v237, s[16:19], s91 offen sc1
    buffer_load_dwordx2 v[10:11], v237, s[16:19], s91 offen offset:128 sc1
    v_bfe_u32 v3, v1, 4, 1
    v_bfe_u32 v2, v1, 2, 2
    v_lshlrev_b32 v4, 7, v2
    v_lshl_add_u32 v4, v213, 3, v4
    v_lshl_add_u32 v4, v3, 5, v4
    v_lshrrev_b32 v2, 1, v2
    v_xor_b32 v2, s28, v2
    v_lshl_add_u32 v4, v2, 6, v4
    s_mul_i32 s37, s28, 28672
    s_add_u32 s37, s37, 65536
    v_add_u32 v205, s37, v4
    v_lshl_add_u32 v204, v212, 9, v205
    v_xor_b32 v207, 64, v205
    v_xor_b32 v206, 64, v204
    s_mul_i32 s90, s26, 9216
    s_add_u32 s90, s90, 122880
    s_xor_b32 s37, s26, 2
    s_mul_i32 s37, s37, 9216
    s_add_u32 s37, s37, 127488
    v_mul_u32_u24 v2, 144, v5
    v_lshl_add_u32 v2, v212, 4, v2
    v_add_u32 v208, s37, v2
    v_add_u32 v209, s90, v2
    v_mul_u32_u24 v2, 144, v211
    v_lshl_add_u32 v2, v213, 5, v2
    v_add_u32 v210, s90, v2
    v_subrev_u32 v2, 8, v1
    s_lshr_b32 s37, s31, 5
    s_mul_i32 s38, s37, 37
    s_lshr_b32 s38, s38, 8
    s_add_u32 s37, s37, 1
    s_mul_i32 s37, s37, 37
    s_lshr_b32 s37, s37, 8
    v_mov_b32 v244, s38
    s_mov_b32 exec_lo, 0
    s_mov_b32 exec_hi, 0xfffffff0
    v_subrev_u32 v2, 36, v1
    v_mov_b32 v244, s37
    s_mov_b64 exec, -1
    v_bfe_u32 v3, v2, 1, 1
    v_lshrrev_b32 v4, 2, v2
    v_lshlrev_b32 v4, 1, v4
    v_lshl_add_u32 v3, v3, 6, v4
    v_and_b32 v2, 1, v2
    v_add_lshl_u32 v3, v3, v2, 7
    v_lshl_add_u32 v3, v244, 11, v3
    v_add_u32 v244, 180224, v3
    s_add_u32 s38, s59, 65536
    s_mov_b64 exec, 0xff
    v_add_u32 v244, s38, v228
    s_mov_b64 exec, -1
    s_mov_b32 s37, 32768
    s_mov_b64 exec, 0x3ffff
    buffer_load_dwordx2 v[6:7], v238, s[16:19], s37 offen sc1
    s_mov_b64 exec, -1
    s_mov_b32 s94, 131072
    s_waitcnt vmcnt(1)
    v_xor_b32 v2, s68, v9
    v_xor_b32 v3, s68, v11
    v_or_b32 v2, v2, v3
    v_cmp_ne_u32 s[22:23], 0, v2
    v_cvt_pk_bf16_f32 v200, v8, v10
    v_and_b32 v201, 0xffff0000, v200
    v_lshlrev_b32 v200, 16, v200
    v_mul_f32 v200, 0xbfb8aa3b, v200
    v_mul_f32 v201, 0xbfb8aa3b, v201
    v_exp_f32 v200, v200
    v_exp_f32 v201, v201
    s_nop 0
    v_add_f32 v200, 1.0, v200
    v_add_f32 v201, 1.0, v201
    v_rcp_f32 v200, v200
    v_rcp_f32 v201, v201
    s_nop 0
    v_cvt_pk_bf16_f32 v200, v200, v201
    v_and_b32 v201, 0xffff0000, v200
    v_lshlrev_b32 v200, 16, v200
    v_sub_f32 v202, 1.0, v200
    v_sub_f32 v203, 1.0, v201
    v_lshlrev_b32 v184, 16, v176
    v_and_b32 v185, 0xffff0000, v176
    v_pk_mul_f32 v[184:185], v[184:185], v[202:203] op_sel_hi:[1,0]
    v_lshlrev_b32 v186, 16, v177
    v_and_b32 v187, 0xffff0000, v177
    v_pk_mul_f32 v[186:187], v[186:187], v[202:203] op_sel_hi:[1,0]
    v_lshlrev_b32 v188, 16, v178
    v_and_b32 v189, 0xffff0000, v178
    v_pk_mul_f32 v[188:189], v[188:189], v[202:203] op_sel_hi:[1,0]
    v_lshlrev_b32 v190, 16, v179
    v_and_b32 v191, 0xffff0000, v179
    v_pk_mul_f32 v[190:191], v[190:191], v[202:203] op_sel_hi:[1,0]
    v_lshlrev_b32 v192, 16, v180
    v_and_b32 v193, 0xffff0000, v180
    v_pk_mul_f32 v[192:193], v[192:193], v[202:203] op_sel:[0,1] op_sel_hi:[1,1]
    v_lshlrev_b32 v194, 16, v181
    v_and_b32 v195, 0xffff0000, v181
    v_pk_mul_f32 v[194:195], v[194:195], v[202:203] op_sel:[0,1] op_sel_hi:[1,1]
    v_lshlrev_b32 v196, 16, v182
    v_and_b32 v197, 0xffff0000, v182
    v_pk_mul_f32 v[196:197], v[196:197], v[202:203] op_sel:[0,1] op_sel_hi:[1,1]
    v_lshlrev_b32 v198, 16, v183
    v_and_b32 v199, 0xffff0000, v183
    v_pk_mul_f32 v[198:199], v[198:199], v[202:203] op_sel:[0,1] op_sel_hi:[1,1]
    s_mov_b32 s94, 131072
    s_mov_b64 exec, 0x3ffff
    s_branch P2_chk
P2_start:
    s_mov_b32 s37, 32768
    s_mov_b32 s94, 131072
    s_mov_b64 exec, 0x3ffff
P2_poll:
    buffer_load_dwordx2 v[6:7], v238, s[16:19], s37 offen sc1
P2_chk:
    s_sub_u32 s94, s94, 1
    s_waitcnt vmcnt(0)
    v_cmp_ne_u64 vcc, s[68:69], v[6:7]
    s_cmp_eq_u32 s94, 0
    s_cbranch_scc1 P2_go
    s_cmp_lg_u64 vcc, 0
    s_cbranch_scc1 P2_poll
P2_go:
    s_mov_b64 exec, -1
    buffer_load_dwordx4 v[40:43], v240, s[16:19], s47 offen sc1
    buffer_load_dwordx4 v[44:47], v240, s[16:19], s47 offen offset:1024 sc1
    buffer_load_dwordx4 a[128:131], v240, s[16:19], s34 offen offset:0 sc1
    buffer_load_dwordx4 a[132:135], v240, s[16:19], s34 offen offset:1024 sc1
    buffer_load_dwordx4 a[136:139], v240, s[16:19], s34 offen offset:2048 sc1
    buffer_load_dwordx4 a[140:143], v240, s[16:19], s34 offen offset:3072 sc1
    buffer_load_dwordx4 a[144:147], v241, s[16:19], s34 offen offset:0 sc1
    buffer_load_dwordx4 a[148:151], v241, s[16:19], s34 offen offset:1024 sc1
    v_mov_b32 v48, 0
    v_mov_b32 v49, 0
    v_pk_mov_b32 v[50:51], v[48:49], v[48:49]
    v_pk_mov_b32 v[52:53], v[48:49], v[48:49]
    v_pk_mov_b32 v[54:55], v[48:49], v[48:49]
    v_pk_mov_b32 v[56:57], v[48:49], v[48:49]
    v_pk_mov_b32 v[58:59], v[48:49], v[48:49]
    v_pk_mov_b32 v[60:61], v[48:49], v[48:49]
    v_pk_mov_b32 v[62:63], v[48:49], v[48:49]
    v_pk_mov_b32 v[64:65], v[48:49], v[48:49]
    v_pk_mov_b32 v[66:67], v[48:49], v[48:49]
    v_pk_mov_b32 v[68:69], v[48:49], v[48:49]
    v_pk_mov_b32 v[70:71], v[48:49], v[48:49]
    v_pk_mov_b32 v[72:73], v[48:49], v[48:49]
    v_pk_mov_b32 v[74:75], v[48:49], v[48:49]
    v_pk_mov_b32 v[76:77], v[48:49], v[48:49]
    v_pk_mov_b32 v[78:79], v[48:49], v[48:49]
    v_pk_mov_b32 v[80:81], v[48:49], v[48:49]
    v_pk_mov_b32 v[82:83], v[48:49], v[48:49]
    v_pk_mov_b32 v[84:85], v[48:49], v[48:49]
    v_pk_mov_b32 v[86:87], v[48:49], v[48:49]
    v_pk_mov_b32 v[88:89], v[48:49], v[48:49]
    v_pk_mov_b32 v[90:91], v[48:49], v[48:49]
    v_pk_mov_b32 v[92:93], v[48:49], v[48:49]
    v_pk_mov_b32 v[94:95], v[48:49], v[48:49]
    v_pk_mov_b32 v[96:97], v[48:49], v[48:49]
    v_pk_mov_b32 v[98:99], v[48:49], v[48:49]
    v_pk_mov_b32 v[100:101], v[48:49], v[48:49]
    v_pk_mov_b32 v[102:103], v[48:49], v[48:49]
    v_pk_mov_b32 v[104:105], v[48:49], v[48:49]
    v_pk_mov_b32 v[106:107], v[48:49], v[48:49]
    v_pk_mov_b32 v[108:109], v[48:49], v[48:49]
    v_pk_mov_b32 v[110:111], v[48:49], v[48:49]
    v_mov_b32 v12, -1
    v_mov_b32 v13, -1
    v_mov_b32 v14, -1
    v_mov_b32 v15, -1
    v_mov_b32 v11, 0x7fffffff
    s_sub_u32 s37, s60, 128
    s_mov_b64 exec, 0xffff
    v_add_u32 v11, s37, v240
    s_mov_b64 exec, 0xff
    v_add_u32 v11, s61, v240
    s_mov_b64 exec, -1
    s_cmp_ge_u32 s29, 28
    s_cbranch_scc1 P2_nl
    s_lshl_b32 s48, s26, 10
    s_add_u32 s48, s48, 61440
    s_movk_i32 s49, 4096
    s_mul_i32 s72, s26, 7168
    s_lshl_b32 s39, s70, 7
    s_add_u32 s72, s72, s39
    s_add_u32 s73, s72, 28672
    s_add_u32 s74, s72, 57344
    s_add_u32 s75, s72, 86016
    s_add_u32 s76, s72, 114688
    s_add_u32 s77, s72, 143360
    s_add_u32 s78, s72, 172032
    s_add_u32 s79, s72, 200704
    s_add_u32 s80, s72, 229376
    s_add_u32 s81, s72, 258048
    s_add_u32 s82, s72, 286720
    s_add_u32 s83, s72, 315392
    s_add_u32 s84, s72, 344064
    s_add_u32 s85, s72, 372736
P2_nl:
    s_mov_b32 s40, 3
    s_waitcnt vmcnt(4)
    v_mfma_f32_32x32x16_bf16 v[112:127], a[128:131], v[40:43], 0
    v_mfma_f32_32x32x16_bf16 v[128:143], a[132:135], v[44:47], v[112:127]
    ds_write_b128 v233, v[40:43] offset:8192
    buffer_load_dwordx4 a[152:155], v241, s[16:19], s34 offen offset:2048 sc1
    buffer_load_dwordx4 a[156:159], v241, s[16:19], s34 offen offset:3072 sc1
    buffer_load_dwordx4 a[160:163], v242, s[16:19], s34 offen offset:0 sc1
    buffer_load_dwordx4 a[164:167], v242, s[16:19], s34 offen offset:1024 sc1
    buffer_load_dwordx4 a[168:171], v242, s[16:19], s34 offen offset:2048 sc1
    buffer_load_dwordx4 a[172:175], v242, s[16:19], s34 offen offset:3072 sc1
    s_nop 4
    v_max3_f32 v8, v128, v129, v130
    v_max3_f32 v8, v8, v131, v132
    s_mov_b32 exec_lo, 0
    v_cvt_pk_bf16_f32 v46, -v8, 0
    s_mov_b32 exec_lo, -1
    ds_write_b128 v233, v[44:47] offset:9216
    v_mfma_f32_32x32x16_bf16 v[112:127], a[132:135], v[44:47], v[112:127]
    s_waitcnt lgkmcnt(0)
    s_barrier
    ds_read_b128 v[16:19], v230 offset:0
    ds_read_b128 v[20:23], v230 offset:1024
    ds_read_b128 v[24:27], v231 offset:4096
    ds_read_b128 v[28:31], v231 offset:5120
    ds_read_b128 v[32:35], v232 offset:8192
    ds_read_b128 v[36:39], v232 offset:9216
    s_nop 3
    v_exp_f32 v112, v112
    v_exp_f32 v113, v113
    v_exp_f32 v114, v114
    v_exp_f32 v115, v115
    s_waitcnt lgkmcnt(4)
    v_mfma_f32_32x32x16_bf16 v[128:143], a[128:131], v[16:19], 0
    buffer_load_dwordx4 a[176:179], v243, s[16:19], s34 offen offset:0 sc1
    buffer_load_dwordx4 a[180:183], v243, s[16:19], s34 offen offset:1024 sc1
    buffer_load_dwordx4 a[184:187], v243, s[16:19], s34 offen offset:2048 sc1
    buffer_load_dwordx4 a[188:191], v243, s[16:19], s34 offen offset:3072 sc1
    v_exp_f32 v116, v116
    v_exp_f32 v117, v117
    v_mfma_f32_32x32x16_bf16 v[128:143], a[132:135], v[20:23], v[128:143]
    buffer_store_dwordx4 v[12:15], v240, s[16:19], s101 offen sc1
    buffer_store_dwordx4 v[12:15], v240, s[16:19], s101 offen offset:1024 sc1
    buffer_store_dwordx4 v[12:15], v11, s[16:19], 0 offen sc1
    s_waitcnt lgkmcnt(0)
    v_exp_f32 v118, v118
    v_exp_f32 v119, v119
    v_exp_f32 v120, v120
    v_exp_f32 v121, v121
    v_exp_f32 v122, v122
    v_exp_f32 v123, v123
    v_exp_f32 v124, v124
    v_exp_f32 v125, v125
    v_exp_f32 v126, v126
    v_exp_f32 v127, v127
    v_mfma_f32_32x32x16_bf16 v[144:159], a[128:131], v[24:27], 0
    v_exp_f32 v128, v128
    v_exp_f32 v129, v129
    v_exp_f32 v130, v130
    v_exp_f32 v131, v131
    v_mfma_f32_32x32x16_bf16 v[144:159], a[132:135], v[28:31], v[144:159]
    s_waitcnt vmcnt(15)
    v_exp_f32 v132, v132
    v_exp_f32 v133, v133
    v_exp_f32 v134, v134
    v_exp_f32 v135, v135
    v_smfmac_f32_32x32x32_bf16 v[96:111], a[136:139], v[112:119], v229
    v_exp_f32 v136, v136
    v_exp_f32 v137, v137
    v_exp_f32 v138, v138
    v_exp_f32 v139, v139
    v_smfmac_f32_32x32x32_bf16 v[96:111], a[140:143], v[120:127], v229
    v_exp_f32 v140, v140
    v_exp_f32 v141, v141
    v_exp_f32 v142, v142
    v_exp_f32 v143, v143
    v_mfma_f32_32x32x16_bf16 v[160:175], a[128:131], v[32:35], 0
    s_barrier
    v_exp_f32 v144, v144
    v_exp_f32 v145, v145
    v_exp_f32 v146, v146
    v_exp_f32 v147, v147
    v_mfma_f32_32x32x16_bf16 v[160:175], a[132:135], v[36:39], v[160:175]
    v_exp_f32 v148, v148
    v_exp_f32 v149, v149
    v_exp_f32 v150, v150
    v_exp_f32 v151, v151
    v_smfmac_f32_32x32x32_bf16 v[48:63], a[136:139], v[128:135], v229
    v_exp_f32 v152, v152
    v_exp_f32 v153, v153
    v_exp_f32 v154, v154
    v_exp_f32 v155, v155
    v_smfmac_f32_32x32x32_bf16 v[48:63], a[140:143], v[136:143], v229
    s_waitcnt vmcnt(11)
    v_exp_f32 v156, v156
    v_exp_f32 v157, v157
    v_exp_f32 v158, v158
    v_exp_f32 v159, v159
    v_mfma_f32_32x32x16_bf16 v[112:127], a[144:147], v[16:19], 0
    v_exp_f32 v160, v160
    v_exp_f32 v161, v161
    v_exp_f32 v162, v162
    v_exp_f32 v163, v163
    v_mfma_f32_32x32x16_bf16 v[112:127], a[148:151], v[20:23], v[112:127]
    v_exp_f32 v164, v164
    v_exp_f32 v165, v165
    v_exp_f32 v166, v166
    v_exp_f32 v167, v167
    v_smfmac_f32_32x32x32_bf16 v[64:79], a[136:139], v[144:151], v229
    v_exp_f32 v168, v168
    v_exp_f32 v169, v169
    v_exp_f32 v170, v170
    v_exp_f32 v171, v171
    v_smfmac_f32_32x32x32_bf16 v[64:79], a[140:143], v[152:159], v229
    s_add_u32 s34, s34, 16384
    v_exp_f32 v172, v172
    v_exp_f32 v173, v173
    v_exp_f32 v174, v174
    v_exp_f32 v175, v175
.p2align 3
P2_loop:
    v_mfma_f32_32x32x16_bf16 v[128:143], a[144:147], v[24:27], 0
    v_exp_f32 v112, v112
    v_exp_f32 v113, v113
    v_exp_f32 v114, v114
    v_exp_f32 v115, v115
    v_mfma_f32_32x32x16_bf16 v[128:143], a[148:151], v[28:31], v[128:143]
    v_exp_f32 v116, v116
    v_exp_f32 v117, v117
    v_exp_f32 v118, v118
    v_exp_f32 v119, v119
    v_smfmac_f32_32x32x32_bf16 v[80:95], a[136:139], v[160:167], v229
    v_exp_f32 v120, v120
    v_exp_f32 v121, v121
    v_exp_f32 v122, v122
    v_exp_f32 v123, v123
    v_smfmac_f32_32x32x32_bf16 v[80:95], a[140:143], v[168:175], v229
    buffer_load_dwordx4 a[128:131], v240, s[16:19], s34 offen offset:0 sc1
    buffer_load_dwordx4 a[132:135], v240, s[16:19], s34 offen offset:1024 sc1
    buffer_load_dwordx4 a[136:139], v240, s[16:19], s34 offen offset:2048 sc1
    buffer_load_dwordx4 a[140:143], v240, s[16:19], s34 offen offset:3072 sc1
    v_exp_f32 v124, v124
    v_exp_f32 v125, v125
    v_exp_f32 v126, v126
    v_exp_f32 v127, v127
    v_mfma_f32_32x32x16_bf16 v[144:159], a[144:147], v[40:43], 0
    v_exp_f32 v128, v128
    v_exp_f32 v129, v129
    v_exp_f32 v130, v130
    v_exp_f32 v131, v131
    v_mfma_f32_32x32x16_bf16 v[144:159], a[148:151], v[44:47], v[144:159]
    v_exp_f32 v132, v132
    v_exp_f32 v133, v133
    v_exp_f32 v134, v134
    v_exp_f32 v135, v135
    v_smfmac_f32_32x32x32_bf16 v[48:63], a[152:155], v[112:119], v229
    v_exp_f32 v136, v136
    v_exp_f32 v137, v137
    v_exp_f32 v138, v138
    v_exp_f32 v139, v139
    v_smfmac_f32_32x32x32_bf16 v[48:63], a[156:159], v[120:127], v229
    buffer_load_dword v236, v227, s[52:55], s56 offen
    s_add_u32 s56, s56, s57
    v_exp_f32 v140, v140
    v_exp_f32 v141, v141
    v_exp_f32 v142, v142
    v_exp_f32 v143, v143
    v_mfma_f32_32x32x16_bf16 v[160:175], a[144:147], v[32:35], 0
    v_exp_f32 v144, v144
    v_exp_f32 v145, v145
    v_exp_f32 v146, v146
    v_exp_f32 v147, v147
    v_mfma_f32_32x32x16_bf16 v[160:175], a[148:151], v[36:39], v[160:175]
    v_exp_f32 v148, v148
    v_exp_f32 v149, v149
    v_exp_f32 v150, v150
    v_exp_f32 v151, v151
    v_smfmac_f32_32x32x32_bf16 v[64:79], a[152:155], v[128:135], v229
    v_exp_f32 v152, v152
    v_exp_f32 v153, v153
    v_exp_f32 v154, v154
    v_exp_f32 v155, v155
    v_smfmac_f32_32x32x32_bf16 v[64:79], a[156:159], v[136:143], v229
    s_waitcnt vmcnt(8)
    v_exp_f32 v156, v156
    v_exp_f32 v157, v157
    v_exp_f32 v158, v158
    v_exp_f32 v159, v159
    v_mfma_f32_32x32x16_bf16 v[112:127], a[160:163], v[16:19], 0
    v_exp_f32 v160, v160
    v_exp_f32 v161, v161
    v_exp_f32 v162, v162
    v_exp_f32 v163, v163
    v_mfma_f32_32x32x16_bf16 v[112:127], a[164:167], v[20:23], v[112:127]
    v_exp_f32 v164, v164
    v_exp_f32 v165, v165
    v_exp_f32 v166, v166
    v_exp_f32 v167, v167
    v_smfmac_f32_32x32x32_bf16 v[96:111], a[152:155], v[144:151], v229
    v_exp_f32 v168, v168
    v_exp_f32 v169, v169
    v_exp_f32 v170, v170
    v_exp_f32 v171, v171
    v_smfmac_f32_32x32x32_bf16 v[96:111], a[156:159], v[152:159], v229
    v_exp_f32 v172, v172
    v_exp_f32 v173, v173
    v_exp_f32 v174, v174
    v_exp_f32 v175, v175
    v_mfma_f32_32x32x16_bf16 v[128:143], a[160:163], v[24:27], 0
    v_exp_f32 v112, v112
    v_exp_f32 v113, v113
    v_exp_f32 v114, v114
    v_exp_f32 v115, v115
    v_mfma_f32_32x32x16_bf16 v[128:143], a[164:167], v[28:31], v[128:143]
    v_exp_f32 v116, v116
    v_exp_f32 v117, v117
    v_exp_f32 v118, v118
    v_exp_f32 v119, v119
    v_smfmac_f32_32x32x32_bf16 v[80:95], a[152:155], v[160:167], v229
    v_exp_f32 v120, v120
    v_exp_f32 v121, v121
    v_exp_f32 v122, v122
    v_exp_f32 v123, v123
    v_smfmac_f32_32x32x32_bf16 v[80:95], a[156:159], v[168:175], v229
    buffer_load_dwordx4 a[144:147], v241, s[16:19], s34 offen offset:0 sc1
    buffer_load_dwordx4 a[148:151], v241, s[16:19], s34 offen offset:1024 sc1
    buffer_load_dwordx4 a[152:155], v241, s[16:19], s34 offen offset:2048 sc1
    buffer_load_dwordx4 a[156:159], v241, s[16:19], s34 offen offset:3072 sc1
    v_exp_f32 v124, v124
    v_exp_f32 v125, v125
    v_exp_f32 v126, v126
    v_exp_f32 v127, v127
    v_mfma_f32_32x32x16_bf16 v[144:159], a[160:163], v[40:43], 0
    v_exp_f32 v128, v128
    v_exp_f32 v129, v129
    v_exp_f32 v130, v130
    v_exp_f32 v131, v131
    v_mfma_f32_32x32x16_bf16 v[144:159], a[164:167], v[44:47], v[144:159]
    v_exp_f32 v132, v132
    v_exp_f32 v133, v133
    v_exp_f32 v134, v134
    v_exp_f32 v135, v135
    v_smfmac_f32_32x32x32_bf16 v[48:63], a[168:171], v[112:119], v229
    v_exp_f32 v136, v136
    v_exp_f32 v137, v137
    v_exp_f32 v138, v138
    v_exp_f32 v139, v139
    v_smfmac_f32_32x32x32_bf16 v[48:63], a[172:175], v[120:127], v229
    v_exp_f32 v140, v140
    v_exp_f32 v141, v141
    v_exp_f32 v142, v142
    v_exp_f32 v143, v143
    v_mfma_f32_32x32x16_bf16 v[160:175], a[160:163], v[32:35], 0
    v_exp_f32 v144, v144
    v_exp_f32 v145, v145
    v_exp_f32 v146, v146
    v_exp_f32 v147, v147
    v_mfma_f32_32x32x16_bf16 v[160:175], a[164:167], v[36:39], v[160:175]
    v_exp_f32 v148, v148
    v_exp_f32 v149, v149
    v_exp_f32 v150, v150
    v_exp_f32 v151, v151
    v_smfmac_f32_32x32x32_bf16 v[64:79], a[168:171], v[128:135], v229
    v_exp_f32 v152, v152
    v_exp_f32 v153, v153
    v_exp_f32 v154, v154
    v_exp_f32 v155, v155
    v_smfmac_f32_32x32x32_bf16 v[64:79], a[172:175], v[136:143], v229
    s_waitcnt vmcnt(8)
    v_exp_f32 v156, v156
    v_exp_f32 v157, v157
    v_exp_f32 v158, v158
    v_exp_f32 v159, v159
    v_mfma_f32_32x32x16_bf16 v[112:127], a[176:179], v[16:19], 0
    v_exp_f32 v160, v160
    v_exp_f32 v161, v161
    v_exp_f32 v162, v162
    v_exp_f32 v163, v163
    v_mfma_f32_32x32x16_bf16 v[112:127], a[180:183], v[20:23], v[112:127]
    v_exp_f32 v164, v164
    v_exp_f32 v165, v165
    v_exp_f32 v166, v166
    v_exp_f32 v167, v167
    v_smfmac_f32_32x32x32_bf16 v[96:111], a[168:171], v[144:151], v229
    v_exp_f32 v168, v168
    v_exp_f32 v169, v169
    v_exp_f32 v170, v170
    v_exp_f32 v171, v171
    v_smfmac_f32_32x32x32_bf16 v[96:111], a[172:175], v[152:159], v229
    v_exp_f32 v172, v172
    v_exp_f32 v173, v173
    v_exp_f32 v174, v174
    v_exp_f32 v175, v175
    v_mfma_f32_32x32x16_bf16 v[128:143], a[176:179], v[24:27], 0
    v_exp_f32 v112, v112
    v_exp_f32 v113, v113
    v_exp_f32 v114, v114
    v_exp_f32 v115, v115
    v_mfma_f32_32x32x16_bf16 v[128:143], a[180:183], v[28:31], v[128:143]
    v_exp_f32 v116, v116
    v_exp_f32 v117, v117
    v_exp_f32 v118, v118
    v_exp_f32 v119, v119
    v_smfmac_f32_32x32x32_bf16 v[80:95], a[168:171], v[160:167], v229
    v_exp_f32 v120, v120
    v_exp_f32 v121, v121
    v_exp_f32 v122, v122
    v_exp_f32 v123, v123
    v_smfmac_f32_32x32x32_bf16 v[80:95], a[172:175], v[168:175], v229
    buffer_load_dwordx4 a[160:163], v242, s[16:19], s34 offen offset:0 sc1
    buffer_load_dwordx4 a[164:167], v242, s[16:19], s34 offen offset:1024 sc1
    buffer_load_dwordx4 a[168:171], v242, s[16:19], s34 offen offset:2048 sc1
    buffer_load_dwordx4 a[172:175], v242, s[16:19], s34 offen offset:3072 sc1
    v_exp_f32 v124, v124
    v_exp_f32 v125, v125
    v_exp_f32 v126, v126
    v_exp_f32 v127, v127
    v_mfma_f32_32x32x16_bf16 v[144:159], a[176:179], v[40:43], 0
    v_exp_f32 v128, v128
    v_exp_f32 v129, v129
    v_exp_f32 v130, v130
    v_exp_f32 v131, v131
    v_mfma_f32_32x32x16_bf16 v[144:159], a[180:183], v[44:47], v[144:159]
    v_exp_f32 v132, v132
    v_exp_f32 v133, v133
    v_exp_f32 v134, v134
    v_exp_f32 v135, v135
    v_smfmac_f32_32x32x32_bf16 v[48:63], a[184:187], v[112:119], v229
    v_exp_f32 v136, v136
    v_exp_f32 v137, v137
    v_exp_f32 v138, v138
    v_exp_f32 v139, v139
    v_smfmac_f32_32x32x32_bf16 v[48:63], a[188:191], v[120:127], v229
    buffer_load_dword v236, v227, s[52:55], s56 offen
    buffer_store_dwordx2 v[220:221], v222, s[16:19], s60 offen offset:64 sc1
    s_add_u32 s56, s56, s57
    v_exp_f32 v140, v140
    v_exp_f32 v141, v141
    v_exp_f32 v142, v142
    v_exp_f32 v143, v143
    v_mfma_f32_32x32x16_bf16 v[160:175], a[176:179], v[32:35], 0
    v_exp_f32 v144, v144
    v_exp_f32 v145, v145
    v_exp_f32 v146, v146
    v_exp_f32 v147, v147
    v_mfma_f32_32x32x16_bf16 v[160:175], a[180:183], v[36:39], v[160:175]
    v_exp_f32 v148, v148
    v_exp_f32 v149, v149
    v_exp_f32 v150, v150
    v_exp_f32 v151, v151
    v_smfmac_f32_32x32x32_bf16 v[64:79], a[184:187], v[128:135], v229
    v_exp_f32 v152, v152
    v_exp_f32 v153, v153
    v_exp_f32 v154, v154
    v_exp_f32 v155, v155
    v_smfmac_f32_32x32x32_bf16 v[64:79], a[188:191], v[136:143], v229
    s_waitcnt vmcnt(8)
    v_exp_f32 v156, v156
    v_exp_f32 v157, v157
    v_exp_f32 v158, v158
    v_exp_f32 v159, v159
    v_mfma_f32_32x32x16_bf16 v[112:127], a[128:131], v[16:19], 0
    v_exp_f32 v160, v160
    v_exp_f32 v161, v161
    v_exp_f32 v162, v162
    v_exp_f32 v163, v163
    v_mfma_f32_32x32x16_bf16 v[112:127], a[132:135], v[20:23], v[112:127]
    v_exp_f32 v164, v164
    v_exp_f32 v165, v165
    v_exp_f32 v166, v166
    v_exp_f32 v167, v167
    v_smfmac_f32_32x32x32_bf16 v[96:111], a[184:187], v[144:151], v229
    v_exp_f32 v168, v168
    v_exp_f32 v169, v169
    v_exp_f32 v170, v170
    v_exp_f32 v171, v171
    v_smfmac_f32_32x32x32_bf16 v[96:111], a[188:191], v[152:159], v229
    v_exp_f32 v172, v172
    v_exp_f32 v173, v173
    v_exp_f32 v174, v174
    v_exp_f32 v175, v175
    v_mfma_f32_32x32x16_bf16 v[128:143], a[128:131], v[24:27], 0
    v_exp_f32 v112, v112
    v_exp_f32 v113, v113
    v_exp_f32 v114, v114
    v_exp_f32 v115, v115
    v_mfma_f32_32x32x16_bf16 v[128:143], a[132:135], v[28:31], v[128:143]
    v_exp_f32 v116, v116
    v_exp_f32 v117, v117
    v_exp_f32 v118, v118
    v_exp_f32 v119, v119
    v_smfmac_f32_32x32x32_bf16 v[80:95], a[184:187], v[160:167], v229
    v_exp_f32 v120, v120
    v_exp_f32 v121, v121
    v_exp_f32 v122, v122
    v_exp_f32 v123, v123
    v_smfmac_f32_32x32x32_bf16 v[80:95], a[188:191], v[168:175], v229
    buffer_load_dwordx4 a[176:179], v243, s[16:19], s34 offen offset:0 sc1
    buffer_load_dwordx4 a[180:183], v243, s[16:19], s34 offen offset:1024 sc1
    buffer_load_dwordx4 a[184:187], v243, s[16:19], s34 offen offset:2048 sc1
    buffer_load_dwordx4 a[188:191], v243, s[16:19], s34 offen offset:3072 sc1
    v_exp_f32 v124, v124
    v_exp_f32 v125, v125
    v_exp_f32 v126, v126
    v_exp_f32 v127, v127
    v_mfma_f32_32x32x16_bf16 v[144:159], a[128:131], v[40:43], 0
    v_exp_f32 v128, v128
    v_exp_f32 v129, v129
    v_exp_f32 v130, v130
    v_exp_f32 v131, v131
    v_mfma_f32_32x32x16_bf16 v[144:159], a[132:135], v[44:47], v[144:159]
    v_exp_f32 v132, v132
    v_exp_f32 v133, v133
    v_exp_f32 v134, v134
    v_exp_f32 v135, v135
    v_smfmac_f32_32x32x32_bf16 v[48:63], a[136:139], v[112:119], v229
    v_exp_f32 v136, v136
    v_exp_f32 v137, v137
    v_exp_f32 v138, v138
    v_exp_f32 v139, v139
    v_smfmac_f32_32x32x32_bf16 v[48:63], a[140:143], v[120:127], v229
    v_exp_f32 v140, v140
    v_exp_f32 v141, v141
    v_exp_f32 v142, v142
    v_exp_f32 v143, v143
    v_mfma_f32_32x32x16_bf16 v[160:175], a[128:131], v[32:35], 0
    v_exp_f32 v144, v144
    v_exp_f32 v145, v145
    v_exp_f32 v146, v146
    v_exp_f32 v147, v147
    v_mfma_f32_32x32x16_bf16 v[160:175], a[132:135], v[36:39], v[160:175]
    v_exp_f32 v148, v148
    v_exp_f32 v149, v149
    v_exp_f32 v150, v150
    v_exp_f32 v151, v151
    v_smfmac_f32_32x32x32_bf16 v[64:79], a[136:139], v[128:135], v229
    v_exp_f32 v152, v152
    v_exp_f32 v153, v153
    v_exp_f32 v154, v154
    v_exp_f32 v155, v155
    v_smfmac_f32_32x32x32_bf16 v[64:79], a[140:143], v[136:143], v229
    s_waitcnt vmcnt(8)
    v_exp_f32 v156, v156
    v_exp_f32 v157, v157
    v_exp_f32 v158, v158
    v_exp_f32 v159, v159
    v_mfma_f32_32x32x16_bf16 v[112:127], a[144:147], v[16:19], 0
    v_exp_f32 v160, v160
    v_exp_f32 v161, v161
    v_exp_f32 v162, v162
    v_exp_f32 v163, v163
    v_mfma_f32_32x32x16_bf16 v[112:127], a[148:151], v[20:23], v[112:127]
    v_exp_f32 v164, v164
    v_exp_f32 v165, v165
    v_exp_f32 v166, v166
    v_exp_f32 v167, v167
    v_smfmac_f32_32x32x32_bf16 v[96:111], a[136:139], v[144:151], v229
    v_exp_f32 v168, v168
    v_exp_f32 v169, v169
    v_exp_f32 v170, v170
    v_exp_f32 v171, v171
    v_smfmac_f32_32x32x32_bf16 v[96:111], a[140:143], v[152:159], v229
    s_add_u32 s34, s34, 16384
    s_sub_u32 s40, s40, 1
    s_cmp_lg_u32 s40, 0
    v_exp_f32 v172, v172
    v_exp_f32 v173, v173
    v_exp_f32 v174, v174
    v_exp_f32 v175, v175
    s_cbranch_scc1 P2_loop
    s_waitcnt vmcnt(4)
    v_mfma_f32_32x32x16_bf16 v[128:143], a[160:163], v[16:19], 0
    v_exp_f32 v112, v112
    v_exp_f32 v113, v113
    v_exp_f32 v114, v114
    v_exp_f32 v115, v115
    v_mfma_f32_32x32x16_bf16 v[128:143], a[164:167], v[20:23], v[128:143]
    v_exp_f32 v116, v116
    v_exp_f32 v117, v117
    v_exp_f32 v118, v118
    v_exp_f32 v119, v119
    v_smfmac_f32_32x32x32_bf16 v[80:95], a[136:139], v[160:167], v229
    v_exp_f32 v120, v120
    v_exp_f32 v121, v121
    v_exp_f32 v122, v122
    v_exp_f32 v123, v123
    v_smfmac_f32_32x32x32_bf16 v[80:95], a[140:143], v[168:175], v229
    s_waitcnt vmcnt(0)
    s_mov_b32 m0, s48
    s_add_u32 m0, m0, s49
    s_nop 0
    buffer_load_dwordx4 v226, s[4:7], s72 offen lds
    s_add_u32 m0, m0, s49
    s_nop 0
    buffer_load_dwordx4 v226, s[4:7], s73 offen lds
    s_add_u32 m0, m0, s49
    s_nop 0
    buffer_load_dwordx4 v226, s[4:7], s74 offen lds
    s_add_u32 m0, m0, s49
    s_nop 0
    buffer_load_dwordx4 v226, s[4:7], s75 offen lds
    s_add_u32 m0, m0, s49
    s_nop 0
    buffer_load_dwordx4 v226, s[4:7], s76 offen lds
    s_add_u32 m0, m0, s49
    s_nop 0
    buffer_load_dwordx4 v226, s[4:7], s77 offen lds
    s_add_u32 m0, m0, s49
    s_nop 0
    buffer_load_dwordx4 v226, s[4:7], s78 offen lds
    v_exp_f32 v124, v124
    v_exp_f32 v125, v125
    v_exp_f32 v126, v126
    v_exp_f32 v127, v127
    v_mfma_f32_32x32x16_bf16 v[144:159], a[176:179], v[16:19], 0
    v_exp_f32 v128, v128
    v_exp_f32 v129, v129
    v_exp_f32 v130, v130
    v_exp_f32 v131, v131
    v_mfma_f32_32x32x16_bf16 v[144:159], a[180:183], v[20:23], v[144:159]
    v_exp_f32 v132, v132
    v_exp_f32 v133, v133
    v_exp_f32 v134, v134
    v_exp_f32 v135, v135
    v_smfmac_f32_32x32x32_bf16 v[48:63], a[152:155], v[112:119], v229
    v_exp_f32 v136, v136
    v_exp_f32 v137, v137
    v_exp_f32 v138, v138
    v_exp_f32 v139, v139
    v_smfmac_f32_32x32x32_bf16 v[48:63], a[156:159], v[120:127], v229
    v_exp_f32 v140, v140
    v_exp_f32 v141, v141
    v_exp_f32 v142, v142
    v_exp_f32 v143, v143
    v_mfma_f32_32x32x16_bf16 v[160:175], a[144:147], v[24:27], 0
    v_exp_f32 v144, v144
    v_exp_f32 v145, v145
    v_exp_f32 v146, v146
    v_exp_f32 v147, v147
    v_mfma_f32_32x32x16_bf16 v[160:175], a[148:151], v[28:31], v[160:175]
    v_exp_f32 v148, v148
    v_exp_f32 v149, v149
    v_exp_f32 v150, v150
    v_exp_f32 v151, v151
    v_smfmac_f32_32x32x32_bf16 v[48:63], a[168:171], v[128:135], v229
    v_exp_f32 v152, v152
    v_exp_f32 v153, v153
    v_exp_f32 v154, v154
    v_exp_f32 v155, v155
    v_smfmac_f32_32x32x32_bf16 v[48:63], a[172:175], v[136:143], v229
    s_add_u32 m0, m0, s49
    s_nop 0
    buffer_load_dwordx4 v226, s[4:7], s79 offen lds
    s_add_u32 m0, m0, s49
    s_nop 0
    buffer_load_dwordx4 v226, s[4:7], s80 offen lds
    s_add_u32 m0, m0, s49
    s_nop 0
    buffer_load_dwordx4 v226, s[4:7], s81 offen lds
    s_add_u32 m0, m0, s49
    s_nop 0
    buffer_load_dwordx4 v226, s[4:7], s82 offen lds
    s_add_u32 m0, m0, s49
    s_nop 0
    buffer_load_dwordx4 v226, s[4:7], s83 offen lds
    s_add_u32 m0, m0, s49
    s_nop 0
    buffer_load_dwordx4 v226, s[4:7], s84 offen lds
    s_add_u32 m0, m0, s49
    s_nop 0
    buffer_load_dwordx4 v226, s[4:7], s85 offen lds
    buffer_load_dwordx2 v[218:219], v244, s[16:19], 0 offen offset:64 sc1
    buffer_load_dwordx2 v[214:215], v225, s[16:19], 0 offen offset:256 sc1
    s_cmp_lt_u32 s95, 28
    v_exp_f32 v156, v156
    v_exp_f32 v157, v157
    v_exp_f32 v158, v158
    v_exp_f32 v159, v159
    v_mfma_f32_32x32x16_bf16 v[112:127], a[160:163], v[24:27], 0
    v_exp_f32 v160, v160
    v_exp_f32 v161, v161
    v_exp_f32 v162, v162
    v_exp_f32 v163, v163
    v_mfma_f32_32x32x16_bf16 v[112:127], a[164:167], v[28:31], v[112:127]
    v_exp_f32 v164, v164
    v_exp_f32 v165, v165
    v_exp_f32 v166, v166
    v_exp_f32 v167, v167
    v_smfmac_f32_32x32x32_bf16 v[48:63], a[184:187], v[144:151], v229
    v_exp_f32 v168, v168
    v_exp_f32 v169, v169
    v_exp_f32 v170, v170
    v_exp_f32 v171, v171
    v_smfmac_f32_32x32x32_bf16 v[48:63], a[188:191], v[152:159], v229
    v_exp_f32 v172, v172
    v_exp_f32 v173, v173
    v_exp_f32 v174, v174
    v_exp_f32 v175, v175
    v_mfma_f32_32x32x16_bf16 v[128:143], a[176:179], v[24:27], 0
    v_exp_f32 v112, v112
    v_exp_f32 v113, v113
    v_exp_f32 v114, v114
    v_exp_f32 v115, v115
    v_mfma_f32_32x32x16_bf16 v[128:143], a[180:183], v[28:31], v[128:143]
    v_exp_f32 v116, v116
    v_exp_f32 v117, v117
    v_exp_f32 v118, v118
    v_exp_f32 v119, v119
    v_smfmac_f32_32x32x32_bf16 v[64:79], a[152:155], v[160:167], v229
    ds_write_b128 v230, v[48:51] offset:0
    v_exp_f32 v120, v120
    v_exp_f32 v121, v121
    v_exp_f32 v122, v122
    v_exp_f32 v123, v123
    v_smfmac_f32_32x32x32_bf16 v[64:79], a[156:159], v[168:175], v229
    ds_write_b128 v230, v[52:55] offset:1024
    v_exp_f32 v124, v124
    v_exp_f32 v125, v125
    v_exp_f32 v126, v126
    v_exp_f32 v127, v127
    v_mfma_f32_32x32x16_bf16 v[144:159], a[144:147], v[32:35], 0
    ds_write_b128 v230, v[56:59] offset:2048
    v_exp_f32 v128, v128
    v_exp_f32 v129, v129
    v_exp_f32 v130, v130
    v_exp_f32 v131, v131
    v_mfma_f32_32x32x16_bf16 v[144:159], a[148:151], v[36:39], v[144:159]
    ds_write_b128 v230, v[60:63] offset:3072
    v_exp_f32 v132, v132
    v_exp_f32 v133, v133
    v_exp_f32 v134, v134
    v_exp_f32 v135, v135
    v_smfmac_f32_32x32x32_bf16 v[64:79], a[168:171], v[112:119], v229
    v_exp_f32 v136, v136
    v_exp_f32 v137, v137
    v_exp_f32 v138, v138
    v_exp_f32 v139, v139
    v_smfmac_f32_32x32x32_bf16 v[64:79], a[172:175], v[120:127], v229
    s_cbranch_scc1 P2_dn0
P2_dn0d:
    v_exp_f32 v140, v140
    v_exp_f32 v141, v141
    v_exp_f32 v142, v142
    v_exp_f32 v143, v143
    v_mfma_f32_32x32x16_bf16 v[160:175], a[160:163], v[32:35], 0
    v_exp_f32 v144, v144
    v_exp_f32 v145, v145
    v_exp_f32 v146, v146
    v_exp_f32 v147, v147
    v_mfma_f32_32x32x16_bf16 v[160:175], a[164:167], v[36:39], v[160:175]
    v_exp_f32 v148, v148
    v_exp_f32 v149, v149
    v_exp_f32 v150, v150
    v_exp_f32 v151, v151
    v_smfmac_f32_32x32x32_bf16 v[64:79], a[184:187], v[128:135], v229
    v_exp_f32 v152, v152
    v_exp_f32 v153, v153
    v_exp_f32 v154, v154
    v_exp_f32 v155, v155
    v_smfmac_f32_32x32x32_bf16 v[64:79], a[188:191], v[136:143], v229
    v_exp_f32 v156, v156
    v_exp_f32 v157, v157
    v_exp_f32 v158, v158
    v_exp_f32 v159, v159
    v_mfma_f32_32x32x16_bf16 v[112:127], a[176:179], v[32:35], 0
    v_exp_f32 v160, v160
    v_exp_f32 v161, v161
    v_exp_f32 v162, v162
    v_exp_f32 v163, v163
    v_mfma_f32_32x32x16_bf16 v[112:127], a[180:183], v[36:39], v[112:127]
    v_exp_f32 v164, v164
    v_exp_f32 v165, v165
    v_exp_f32 v166, v166
    v_exp_f32 v167, v167
    v_smfmac_f32_32x32x32_bf16 v[80:95], a[152:155], v[144:151], v229
    ds_write_b128 v231, v[64:67] offset:0
    v_exp_f32 v168, v168
    v_exp_f32 v169, v169
    v_exp_f32 v170, v170
    v_exp_f32 v171, v171
    v_smfmac_f32_32x32x32_bf16 v[80:95], a[156:159], v[152:159], v229
    ds_write_b128 v231, v[68:71] offset:1024
    v_exp_f32 v172, v172
    v_exp_f32 v173, v173
    v_exp_f32 v174, v174
    v_exp_f32 v175, v175
    v_mfma_f32_32x32x16_bf16 v[128:143], a[144:147], v[40:43], 0
    ds_write_b128 v231, v[72:75] offset:2048
    v_exp_f32 v112, v112
    v_exp_f32 v113, v113
    v_exp_f32 v114, v114
    v_exp_f32 v115, v115
    v_mfma_f32_32x32x16_bf16 v[128:143], a[148:151], v[44:47], v[128:143]
    ds_write_b128 v231, v[76:79] offset:3072
    v_exp_f32 v116, v116
    v_exp_f32 v117, v117
    v_exp_f32 v118, v118
    v_exp_f32 v119, v119
    v_smfmac_f32_32x32x32_bf16 v[80:95], a[168:171], v[160:167], v229
    s_cbranch_scc1 P2_dn1
P2_dn1d:
    v_exp_f32 v120, v120
    v_exp_f32 v121, v121
    v_exp_f32 v122, v122
    v_exp_f32 v123, v123
    v_smfmac_f32_32x32x32_bf16 v[80:95], a[172:175], v[168:175], v229
    v_exp_f32 v124, v124
    v_exp_f32 v125, v125
    v_exp_f32 v126, v126
    v_exp_f32 v127, v127
    v_mfma_f32_32x32x16_bf16 v[144:159], a[160:163], v[40:43], 0
    v_exp_f32 v128, v128
    v_exp_f32 v129, v129
    v_exp_f32 v130, v130
    v_exp_f32 v131, v131
    v_mfma_f32_32x32x16_bf16 v[144:159], a[164:167], v[44:47], v[144:159]
    v_exp_f32 v132, v132
    v_exp_f32 v133, v133
    v_exp_f32 v134, v134
    v_exp_f32 v135, v135
    v_smfmac_f32_32x32x32_bf16 v[80:95], a[184:187], v[112:119], v229
    v_exp_f32 v136, v136
    v_exp_f32 v137, v137
    v_exp_f32 v138, v138
    v_exp_f32 v139, v139
    v_smfmac_f32_32x32x32_bf16 v[80:95], a[188:191], v[120:127], v229
    v_exp_f32 v140, v140
    v_exp_f32 v141, v141
    v_exp_f32 v142, v142
    v_exp_f32 v143, v143
    v_mfma_f32_32x32x16_bf16 v[160:175], a[176:179], v[40:43], 0
    v_exp_f32 v144, v144
    v_exp_f32 v145, v145
    v_exp_f32 v146, v146
    v_exp_f32 v147, v147
    v_mfma_f32_32x32x16_bf16 v[160:175], a[180:183], v[44:47], v[160:175]
    v_exp_f32 v148, v148
    v_exp_f32 v149, v149
    v_exp_f32 v150, v150
    v_exp_f32 v151, v151
    v_smfmac_f32_32x32x32_bf16 v[96:111], a[152:155], v[128:135], v229
    ds_write_b128 v232, v[80:83] offset:0
    ds_write_b128 v232, v[84:87] offset:1024
    v_exp_f32 v152, v152
    v_exp_f32 v153, v153
    v_exp_f32 v154, v154
    v_exp_f32 v155, v155
    v_smfmac_f32_32x32x32_bf16 v[96:111], a[156:159], v[136:143], v229
    ds_write_b128 v232, v[88:91] offset:2048
    ds_write_b128 v232, v[92:95] offset:3072
    v_exp_f32 v156, v156
    v_exp_f32 v157, v157
    v_exp_f32 v158, v158
    v_exp_f32 v159, v159
    v_exp_f32 v160, v160
    v_exp_f32 v161, v161
    v_smfmac_f32_32x32x32_bf16 v[96:111], a[168:171], v[144:151], v229
    s_waitcnt vmcnt(0) lgkmcnt(0)
    s_barrier
    ds_read_b128 v[48:51], v233 offset:0
    ds_read_b128 v[52:55], v233 offset:1024
    ds_read_b128 v[56:59], v233 offset:2048
    ds_read_b128 v[60:63], v233 offset:3072
    v_exp_f32 v162, v162
    v_exp_f32 v163, v163
    v_exp_f32 v164, v164
    v_exp_f32 v165, v165
    v_smfmac_f32_32x32x32_bf16 v[96:111], a[172:175], v[152:159], v229
    ds_read_b128 v[64:67], v233 offset:4096
    ds_read_b128 v[68:71], v233 offset:5120
    ds_read_b128 v[72:75], v233 offset:6144
    ds_read_b128 v[76:79], v233 offset:7168
    v_exp_f32 v166, v166
    v_exp_f32 v167, v167
    v_exp_f32 v168, v168
    v_exp_f32 v169, v169
    v_smfmac_f32_32x32x32_bf16 v[96:111], a[184:187], v[160:167], v229
    buffer_load_dwordx2 v[216:217], v223, s[16:19], s58 offen sc1
    ds_read_b128 v[80:83], v233 offset:8192
    ds_read_b128 v[84:87], v233 offset:9216
    ds_read_b128 v[88:91], v233 offset:10240
    ds_read_b128 v[92:95], v233 offset:11264
    v_exp_f32 v170, v170
    v_exp_f32 v171, v171
    v_exp_f32 v172, v172
    v_exp_f32 v173, v173
    v_exp_f32 v174, v174
    v_exp_f32 v175, v175
    s_waitcnt lgkmcnt(4)
    v_pk_add_f32 v[48:49], v[48:49], v[64:65]
    v_smfmac_f32_32x32x32_bf16 v[96:111], a[188:191], v[168:175], v229
    v_pk_add_f32 v[50:51], v[50:51], v[66:67]
    v_pk_add_f32 v[52:53], v[52:53], v[68:69]
    v_pk_add_f32 v[54:55], v[54:55], v[70:71]
    v_pk_add_f32 v[56:57], v[56:57], v[72:73]
    v_pk_add_f32 v[58:59], v[58:59], v[74:75]
    v_pk_add_f32 v[60:61], v[60:61], v[76:77]
    v_pk_add_f32 v[62:63], v[62:63], v[78:79]
    s_waitcnt lgkmcnt(0)
    v_pk_add_f32 v[48:49], v[48:49], v[80:81]
    v_pk_add_f32 v[50:51], v[50:51], v[82:83]
    v_pk_add_f32 v[52:53], v[52:53], v[84:85]
    v_pk_add_f32 v[54:55], v[54:55], v[86:87]
    v_pk_add_f32 v[56:57], v[56:57], v[88:89]
    v_pk_add_f32 v[58:59], v[58:59], v[90:91]
    v_pk_add_f32 v[60:61], v[60:61], v[92:93]
    v_pk_add_f32 v[62:63], v[62:63], v[94:95]
    v_pk_add_f32 v[60:61], v[60:61], v[108:109]
    v_mov_b32 v8, v60
    v_mov_b32 v11, v60
    v_pk_add_f32 v[48:49], v[48:49], v[96:97]
    v_pk_add_f32 v[50:51], v[50:51], v[98:99]
    v_permlane32_swap_b32 v8, v11
    v_pk_add_f32 v[52:53], v[52:53], v[100:101]
    v_pk_add_f32 v[54:55], v[54:55], v[102:103]
    v_rcp_f32 v10, v11
    v_pk_add_f32 v[56:57], v[56:57], v[104:105]
    v_pk_add_f32 v[58:59], v[58:59], v[106:107]
    v_pk_add_f32 v[62:63], v[62:63], v[110:111]
    v_pk_add_f32 v[112:113], v[48:49], v[50:51]
    v_pk_add_f32 v[114:115], v[52:53], v[54:55]
    v_pk_add_f32 v[116:117], v[56:57], v[58:59]
    v_pk_add_f32 v[118:119], v[60:61], v[62:63]
    v_pk_add_f32 v[112:113], v[112:113], v[114:115]
    v_pk_add_f32 v[116:117], v[116:117], v[118:119]
    v_pk_fma_f32 v[112:113], v[10:11], s[66:67], v[112:113]
    v_pk_add_f32 v[112:113], v[112:113], v[116:117]
    v_add_f32 v112, v112, v113
    v_cmp_class_f32 vcc, v112, s63
P2_finish:
    v_pk_mul_f32 v[48:49], v[48:49], v[10:11] op_sel_hi:[1,0]
    v_pk_mul_f32 v[50:51], v[50:51], v[10:11] op_sel_hi:[1,0]
    v_pk_mul_f32 v[52:53], v[52:53], v[10:11] op_sel_hi:[1,0]
    v_pk_mul_f32 v[54:55], v[54:55], v[10:11] op_sel_hi:[1,0]
    s_cmp_lg_u64 vcc, 0
    s_cbranch_scc1 P2_fallback
    v_cvt_pk_bf16_f32 v112, v48, v49
    v_cvt_pk_bf16_f32 v113, v50, v51
    v_cvt_pk_bf16_f32 v114, v52, v53
    v_cvt_pk_bf16_f32 v115, v54, v55
    buffer_store_dwordx4 v[112:115], v234, s[16:19], s101 offen sc1
    v_mul_f32 v60, v60, v235
    v_pk_mul_f32 v[56:57], v[56:57], v[10:11] op_sel_hi:[1,0]
    v_pk_mul_f32 v[58:59], v[58:59], v[10:11] op_sel_hi:[1,0]
    v_pk_mul_f32 v[62:63], v[62:63], v[10:11] op_sel_hi:[1,0]
    v_pk_mul_f32 v[60:61], v[60:61], v[10:11] op_sel_hi:[1,0]
    v_cvt_pk_bf16_f32 v116, v56, v57
    v_cvt_pk_bf16_f32 v117, v58, v59
    v_cvt_pk_bf16_f32 v118, v60, v61
    v_cvt_pk_bf16_f32 v119, v62, v63
    buffer_store_dwordx4 v[116:119], v234, s[16:19], s101 offen offset:1024 sc1
    buffer_store_dwordx2 v[220:221], v222, s[16:19], s61 offen offset:0 sc1
    s_cmp_ge_u32 s29, 28
    s_cbranch_scc1 P3_spare
    v_cmp_ne_u64 vcc, s[68:69], v[218:219]
    v_cmp_ne_u32 s[44:45], s68, v215
    s_mov_b32 s41, 2
    s_and_b32 s43, s70, 3
    s_or_b64 vcc, vcc, s[22:23]
    s_or_b64 vcc, vcc, s[44:45]
    s_cbranch_scc1 P3_fpwait
P3_fpok:
    v_and_b32 v2, 0x7ff, v214
    v_sub_u32 v2, 2047, v2
    v_lshrrev_b32 v3, 5, v2
    v_cmp_eq_u32 vcc, s30, v3
    v_ashrrev_i32 v3, 31, v214
    s_mov_b32 s94, 131072
    s_and_b32 s44, vcc_lo, 0xff
    s_cbranch_scc1 P3_y0
P3_y0d:
    s_waitcnt vmcnt(3)
    s_branch P3_t1
P3_t0:
    buffer_load_dwordx2 v[216:217], v223, s[16:19], s58 offen sc1
    s_sub_u32 s94, s94, 1
    s_waitcnt vmcnt(0)
P3_t1:
    v_cmp_ne_u64 vcc, s[68:69], v[216:217]
    s_cmp_eq_u32 s94, 0
    s_cbranch_scc1 P3_ld
    s_lshr_b32 s37, vcc_lo, 1
    s_or_b32 s37, s37, vcc_lo
    s_and_b32 s37, s37, 0x55
    s_bcnt1_i32_b32 s38, s37
    s_cmp_gt_u32 s38, 2
    s_cbranch_scc1 P3_t0
    s_ff1_i32_b32 s38, s37
    s_lshr_b32 s38, s38, 1
    s_cmp_lg_u32 s37, 0
    s_cselect_b32 s43, s38, s43
P3_ld:
    s_xor_b32 s52, s43, 2
    s_lshl_b32 s37, s52, 12
    s_add_u32 s24, s37, s36
    buffer_load_dwordx4 a[128:131], v240, s[16:19], s24 offen offset:0 sc1
    buffer_load_dwordx4 a[132:135], v240, s[16:19], s24 offen offset:1024 sc1
    buffer_load_dwordx4 a[136:139], v240, s[16:19], s24 offen offset:2048 sc1
    buffer_load_dwordx4 a[140:143], v240, s[16:19], s24 offen offset:3072 sc1
    s_xor_b32 s53, s43, 3
    s_lshl_b32 s37, s53, 12
    s_add_u32 s25, s37, s36
    buffer_load_dwordx4 a[144:147], v240, s[16:19], s25 offen offset:0 sc1
    buffer_load_dwordx4 a[148:151], v240, s[16:19], s25 offen offset:1024 sc1
    buffer_load_dwordx4 a[152:155], v240, s[16:19], s25 offen offset:2048 sc1
    buffer_load_dwordx4 a[156:159], v240, s[16:19], s25 offen offset:3072 sc1
    s_xor_b32 s54, s43, 1
    s_lshl_b32 s37, s54, 12
    s_add_u32 s27, s37, s36
    s_xor_b32 s55, s43, 0
    s_lshl_b32 s37, s55, 12
    s_add_u32 s50, s37, s36
    s_mul_i32 s37, s52, 7168
    v_add_u32 v6, s37, v204
    v_add_u32 v7, s37, v205
    v_add_u32 v8, s37, v206
    v_add_u32 v9, s37, v207
    ds_read_b64_tr_b16 a[4:5], v8 offset:0
    ds_read_b64_tr_b16 a[6:7], v8 offset:1024
    ds_read_b64_tr_b16 a[0:1], v6 offset:0
    ds_read_b64_tr_b16 a[2:3], v6 offset:1024
    ds_read_b64_tr_b16 a[12:13], v8 offset:2048
    ds_read_b64_tr_b16 a[14:15], v9 offset:3072
    ds_read_b64_tr_b16 a[8:9], v6 offset:2048
    ds_read_b64_tr_b16 a[10:11], v7 offset:3072
    s_mul_i32 s37, s53, 7168
    v_add_u32 v245, s37, v204
    v_add_u32 v246, s37, v205
    v_add_u32 v247, s37, v206
    v_add_u32 v248, s37, v207
    s_mul_i32 s37, s54, 7168
    v_add_u32 v249, s37, v204
    v_add_u32 v250, s37, v205
    v_add_u32 v251, s37, v206
    v_add_u32 v252, s37, v207
    s_waitcnt lgkmcnt(6)
    ds_read_b64_tr_b16 a[20:21], v8 offset:3584
    ds_read_b64_tr_b16 a[22:23], v8 offset:4608
    ds_read_b64_tr_b16 a[16:17], v6 offset:3584
    ds_read_b64_tr_b16 a[18:19], v6 offset:4608
    ds_read_b64_tr_b16 a[28:29], v8 offset:5632
    ds_read_b64_tr_b16 a[30:31], v9 offset:6656
    ds_read_b64_tr_b16 a[24:25], v6 offset:5632
    ds_read_b64_tr_b16 a[26:27], v7 offset:6656
    s_waitcnt lgkmcnt(6)
    ds_read_b64_tr_b16 a[36:37], v247 offset:0
    ds_read_b64_tr_b16 a[38:39], v247 offset:1024
    ds_read_b64_tr_b16 a[32:33], v245 offset:0
    ds_read_b64_tr_b16 a[34:35], v245 offset:1024
    ds_read_b64_tr_b16 a[44:45], v247 offset:2048
    ds_read_b64_tr_b16 a[46:47], v248 offset:3072
    ds_read_b64_tr_b16 a[40:41], v245 offset:2048
    ds_read_b64_tr_b16 a[42:43], v246 offset:3072
    s_mul_i32 s37, s55, 7168
    v_add_u32 v6, s37, v204
    v_add_u32 v7, s37, v205
    v_add_u32 v8, s37, v206
    v_add_u32 v9, s37, v207
    s_mov_b32 s40, 4096
    s_waitcnt vmcnt(6)
    v_accvgpr_read_b32 v4, a128
    v_accvgpr_read_b32 v5, a132
    v_max_u32 v4, v4, v5
    v_cmp_eq_u32 vcc, -1, v4
    s_waitcnt lgkmcnt(8)
    s_nop 0
    s_cmp_lg_u64 vcc, 0
    s_cbranch_scc1 P3_r0
P3_kd0:
    v_mfma_f32_32x32x16_bf16 v[32:47], a[4:7], a[128:131], 0
    buffer_load_dwordx4 a[160:163], v240, s[16:19], s27 offen offset:0 sc1
    buffer_load_dwordx4 a[164:167], v240, s[16:19], s27 offen offset:1024 sc1
    buffer_load_dwordx4 a[168:171], v240, s[16:19], s27 offen offset:2048 sc1
    buffer_load_dwordx4 a[172:175], v240, s[16:19], s27 offen offset:3072 sc1
    s_waitcnt lgkmcnt(4)
    ds_read_b64_tr_b16 a[52:53], v247 offset:3584
    ds_read_b64_tr_b16 a[54:55], v247 offset:4608
    v_mfma_f32_32x32x16_bf16 v[16:31], a[0:3], a[128:131], 0
    ds_read_b64_tr_b16 a[48:49], v245 offset:3584
    ds_read_b64_tr_b16 a[50:51], v245 offset:4608
    ds_read_b64_tr_b16 a[60:61], v247 offset:5632
    ds_read_b64_tr_b16 a[62:63], v248 offset:6656
    v_mfma_f32_32x32x16_bf16 v[32:47], a[12:15], a[132:135], v[32:47]
    ds_read_b64_tr_b16 a[56:57], v245 offset:5632
    ds_read_b64_tr_b16 a[58:59], v246 offset:6656
    s_waitcnt vmcnt(8)
    v_accvgpr_read_b32 v4, a136
    v_accvgpr_read_b32 v5, a140
    v_max_u32 v4, v4, v5
    v_cmp_eq_u32 vcc, -1, v4
    v_mfma_f32_32x32x16_bf16 v[16:31], a[8:11], a[132:135], v[16:31]
    s_waitcnt lgkmcnt(8)
    s_cmp_lg_u64 vcc, 0
    s_cbranch_scc1 P3_r1
P3_kd1:
    v_mfma_f32_32x32x16_bf16 v[32:47], a[20:23], a[136:139], v[32:47]
    buffer_load_dwordx4 a[176:179], v240, s[16:19], s50 offen offset:0 sc1
    buffer_load_dwordx4 a[180:183], v240, s[16:19], s50 offen offset:1024 sc1
    buffer_load_dwordx4 a[184:187], v240, s[16:19], s50 offen offset:2048 sc1
    buffer_load_dwordx4 a[188:191], v240, s[16:19], s50 offen offset:3072 sc1
    s_waitcnt lgkmcnt(4)
    ds_read_b64_tr_b16 a[68:69], v251 offset:0
    ds_read_b64_tr_b16 a[70:71], v251 offset:1024
    v_mfma_f32_32x32x16_bf16 v[16:31], a[16:19], a[136:139], v[16:31]
    ds_read_b64_tr_b16 a[64:65], v249 offset:0
    ds_read_b64_tr_b16 a[66:67], v249 offset:1024
    ds_read_b64_tr_b16 a[76:77], v251 offset:2048
    ds_read_b64_tr_b16 a[78:79], v252 offset:3072
    v_mfma_f32_32x32x16_bf16 v[32:47], a[28:31], a[140:143], v[32:47]
    ds_read_b64_tr_b16 a[72:73], v249 offset:2048
    ds_read_b64_tr_b16 a[74:75], v250 offset:3072
    s_waitcnt vmcnt(10)
    v_accvgpr_read_b32 v4, a144
    v_accvgpr_read_b32 v5, a148
    v_max_u32 v4, v4, v5
    v_cmp_eq_u32 vcc, -1, v4
    v_mfma_f32_32x32x16_bf16 v[16:31], a[24:27], a[140:143], v[16:31]
    s_waitcnt lgkmcnt(8)
    s_cmp_lg_u64 vcc, 0
    s_cbranch_scc1 P3_r2
P3_kd2:
    v_mfma_f32_32x32x16_bf16 v[64:79], a[36:39], a[144:147], 0
    s_waitcnt lgkmcnt(4)
    ds_read_b64_tr_b16 a[84:85], v251 offset:3584
    ds_read_b64_tr_b16 a[86:87], v251 offset:4608
    v_mfma_f32_32x32x16_bf16 v[48:63], a[32:35], a[144:147], 0
    ds_read_b64_tr_b16 a[80:81], v249 offset:3584
    ds_read_b64_tr_b16 a[82:83], v249 offset:4608
    ds_read_b64_tr_b16 a[92:93], v251 offset:5632
    ds_read_b64_tr_b16 a[94:95], v252 offset:6656
    v_mfma_f32_32x32x16_bf16 v[64:79], a[44:47], a[148:151], v[64:79]
    ds_read_b64_tr_b16 a[88:89], v249 offset:5632
    ds_read_b64_tr_b16 a[90:91], v250 offset:6656
    s_waitcnt vmcnt(8)
    v_accvgpr_read_b32 v4, a152
    v_accvgpr_read_b32 v5, a156
    v_max_u32 v4, v4, v5
    v_cmp_eq_u32 vcc, -1, v4
    v_mfma_f32_32x32x16_bf16 v[48:63], a[40:43], a[148:151], v[48:63]
    s_waitcnt lgkmcnt(8)
    s_cmp_lg_u64 vcc, 0
    s_cbranch_scc1 P3_r3
P3_kd3:
    v_mfma_f32_32x32x16_bf16 v[64:79], a[52:55], a[152:155], v[64:79]
    s_waitcnt lgkmcnt(4)
    ds_read_b64_tr_b16 a[100:101], v8 offset:0
    ds_read_b64_tr_b16 a[102:103], v8 offset:1024
    v_mfma_f32_32x32x16_bf16 v[48:63], a[48:51], a[152:155], v[48:63]
    ds_read_b64_tr_b16 a[96:97], v6 offset:0
    ds_read_b64_tr_b16 a[98:99], v6 offset:1024
    ds_read_b64_tr_b16 a[108:109], v8 offset:2048
    ds_read_b64_tr_b16 a[110:111], v9 offset:3072
    v_mfma_f32_32x32x16_bf16 v[64:79], a[60:63], a[156:159], v[64:79]
    ds_read_b64_tr_b16 a[104:105], v6 offset:2048
    ds_read_b64_tr_b16 a[106:107], v7 offset:3072
    s_waitcnt vmcnt(6)
    v_accvgpr_read_b32 v4, a160
    v_accvgpr_read_b32 v5, a164
    v_max_u32 v4, v4, v5
    v_cmp_eq_u32 vcc, -1, v4
    v_mfma_f32_32x32x16_bf16 v[48:63], a[56:59], a[156:159], v[48:63]
    s_waitcnt lgkmcnt(8)
    s_cmp_lg_u64 vcc, 0
    s_cbranch_scc1 P3_r4
P3_kd4:
    v_mfma_f32_32x32x16_bf16 v[96:111], a[68:71], a[160:163], 0
    s_waitcnt lgkmcnt(4)
    ds_read_b64_tr_b16 a[116:117], v8 offset:3584
    ds_read_b64_tr_b16 a[118:119], v8 offset:4608
    v_mfma_f32_32x32x16_bf16 v[80:95], a[64:67], a[160:163], 0
    ds_read_b64_tr_b16 a[112:113], v6 offset:3584
    ds_read_b64_tr_b16 a[114:115], v6 offset:4608
    ds_read_b64_tr_b16 a[124:125], v8 offset:5632
    ds_read_b64_tr_b16 a[126:127], v9 offset:6656
    v_mfma_f32_32x32x16_bf16 v[96:111], a[76:79], a[164:167], v[96:111]
    ds_read_b64_tr_b16 a[120:121], v6 offset:5632
    ds_read_b64_tr_b16 a[122:123], v7 offset:6656
    s_waitcnt vmcnt(4)
    v_accvgpr_read_b32 v4, a168
    v_accvgpr_read_b32 v5, a172
    v_max_u32 v4, v4, v5
    v_cmp_eq_u32 vcc, -1, v4
    v_mfma_f32_32x32x16_bf16 v[80:95], a[72:75], a[164:167], v[80:95]
    s_waitcnt lgkmcnt(8)
    s_cmp_lg_u64 vcc, 0
    s_cbranch_scc1 P3_r5
P3_kd5:
    v_mfma_f32_32x32x16_bf16 v[96:111], a[84:87], a[168:171], v[96:111]
    s_waitcnt lgkmcnt(0)
    v_pk_add_f32 v[32:33], v[32:33], v[64:65]
    v_pk_add_f32 v[34:35], v[34:35], v[66:67]
    v_pk_add_f32 v[36:37], v[36:37], v[68:69]
    v_pk_add_f32 v[38:39], v[38:39], v[70:71]
    v_mfma_f32_32x32x16_bf16 v[80:95], a[80:83], a[168:171], v[80:95]
    v_pk_add_f32 v[40:41], v[40:41], v[72:73]
    v_pk_add_f32 v[42:43], v[42:43], v[74:75]
    v_pk_add_f32 v[44:45], v[44:45], v[76:77]
    v_pk_add_f32 v[46:47], v[46:47], v[78:79]
    v_mfma_f32_32x32x16_bf16 v[96:111], a[92:95], a[172:175], v[96:111]
    s_waitcnt vmcnt(2)
    v_accvgpr_read_b32 v4, a176
    v_accvgpr_read_b32 v5, a180
    v_max_u32 v4, v4, v5
    v_cmp_eq_u32 vcc, -1, v4
    v_mfma_f32_32x32x16_bf16 v[80:95], a[88:91], a[172:175], v[80:95]
    s_cmp_lg_u64 vcc, 0
    s_cbranch_scc1 P3_r6
P3_kd6:
    v_mfma_f32_32x32x16_bf16 v[128:143], a[100:103], a[176:179], 0
    s_waitcnt lgkmcnt(0)
    v_pk_add_f32 v[16:17], v[16:17], v[48:49]
    v_pk_add_f32 v[18:19], v[18:19], v[50:51]
    v_pk_add_f32 v[20:21], v[20:21], v[52:53]
    v_pk_add_f32 v[22:23], v[22:23], v[54:55]
    v_mfma_f32_32x32x16_bf16 v[112:127], a[96:99], a[176:179], 0
    v_pk_add_f32 v[24:25], v[24:25], v[56:57]
    v_pk_add_f32 v[26:27], v[26:27], v[58:59]
    v_pk_add_f32 v[28:29], v[28:29], v[60:61]
    v_pk_add_f32 v[30:31], v[30:31], v[62:63]
    v_mfma_f32_32x32x16_bf16 v[128:143], a[108:111], a[180:183], v[128:143]
    s_waitcnt vmcnt(0)
    v_accvgpr_read_b32 v4, a184
    v_accvgpr_read_b32 v5, a188
    v_max_u32 v4, v4, v5
    v_cmp_eq_u32 vcc, -1, v4
    v_mfma_f32_32x32x16_bf16 v[112:127], a[104:107], a[180:183], v[112:127]
    s_cmp_lg_u64 vcc, 0
    s_cbranch_scc1 P3_r7
P3_kd7:
    s_cmp_lg_u32 s44, 0
    s_cbranch_scc1 P3_ya
    v_mfma_f32_32x32x16_bf16 v[128:143], a[116:119], a[184:187], v[128:143]
    v_mfma_f32_32x32x16_bf16 v[112:127], a[112:115], a[184:187], v[112:127]
    v_mfma_f32_32x32x16_bf16 v[128:143], a[124:127], a[188:191], v[128:143]
    v_mfma_f32_32x32x16_bf16 v[112:127], a[120:123], a[188:191], v[112:127]
    buffer_store_dwordx2 v[220:221], v222, s[16:19], s60 offen offset:0 sc1
    s_nop 9
P3_yad:
    v_pk_add_f32 v[96:97], v[96:97], v[128:129]
    v_pk_add_f32 v[98:99], v[98:99], v[130:131]
    v_pk_add_f32 v[100:101], v[100:101], v[132:133]
    v_pk_add_f32 v[102:103], v[102:103], v[134:135]
    v_pk_add_f32 v[104:105], v[104:105], v[136:137]
    v_pk_add_f32 v[106:107], v[106:107], v[138:139]
    v_pk_add_f32 v[108:109], v[108:109], v[140:141]
    v_pk_add_f32 v[110:111], v[110:111], v[142:143]
    v_pk_add_f32 v[32:33], v[32:33], v[96:97]
    v_cmp_u_f32 vcc, v32, v32
    v_pk_add_f32 v[34:35], v[34:35], v[98:99]
    ds_write_b128 v208, v[32:35] offset:0
    v_pk_add_f32 v[36:37], v[36:37], v[100:101]
    v_pk_add_f32 v[38:39], v[38:39], v[102:103]
    ds_write_b128 v208, v[36:39] offset:32
    s_cmp_lg_u64 vcc, 0
    s_cbranch_scc1 P3_slow
P3_fin:
    v_pk_add_f32 v[40:41], v[40:41], v[104:105]
    v_pk_add_f32 v[42:43], v[42:43], v[106:107]
    ds_write_b128 v208, v[40:43] offset:64
    v_pk_add_f32 v[44:45], v[44:45], v[108:109]
    v_pk_add_f32 v[46:47], v[46:47], v[110:111]
    ds_write_b128 v208, v[44:47] offset:96
    v_pk_add_f32 v[80:81], v[80:81], v[112:113]
    v_pk_add_f32 v[82:83], v[82:83], v[114:115]
    v_pk_add_f32 v[84:85], v[84:85], v[116:117]
    v_pk_add_f32 v[86:87], v[86:87], v[118:119]
    v_pk_add_f32 v[88:89], v[88:89], v[120:121]
    v_pk_add_f32 v[90:91], v[90:91], v[122:123]
    v_pk_add_f32 v[92:93], v[92:93], v[124:125]
    v_pk_add_f32 v[94:95], v[94:95], v[126:127]
    v_pk_add_f32 v[16:17], v[16:17], v[80:81]
    v_pk_add_f32 v[18:19], v[18:19], v[82:83]
    ds_write_b128 v209, v[16:19] offset:0
    v_pk_add_f32 v[20:21], v[20:21], v[84:85]
    v_pk_add_f32 v[22:23], v[22:23], v[86:87]
    ds_write_b128 v209, v[20:23] offset:32
    v_pk_add_f32 v[24:25], v[24:25], v[88:89]
    v_pk_add_f32 v[26:27], v[26:27], v[90:91]
    ds_write_b128 v209, v[24:27] offset:64
    v_pk_add_f32 v[28:29], v[28:29], v[92:93]
    v_pk_add_f32 v[30:31], v[30:31], v[94:95]
    ds_write_b128 v209, v[28:31] offset:96
    s_cmp_lg_u32 s44, 0
    s_cbranch_scc1 P3_y
P3_yd:
    s_waitcnt lgkmcnt(4)
    s_barrier
    ds_read_b128 v[48:51], v210 offset:0
    ds_read_b128 v[52:55], v210 offset:16
    ds_read_b128 v[56:59], v210 offset:4608
    ds_read_b128 v[60:63], v210 offset:4624
    ds_read_b128 v[64:67], v210 offset:2304
    ds_read_b128 v[68:71], v210 offset:2320
    ds_read_b128 v[72:75], v210 offset:6912
    ds_read_b128 v[76:79], v210 offset:6928
    s_waitcnt lgkmcnt(4)
    v_pk_add_f32 v[48:49], v[48:49], v[56:57]
    v_pk_add_f32 v[50:51], v[50:51], v[58:59]
    v_pk_add_f32 v[52:53], v[52:53], v[60:61]
    v_pk_add_f32 v[54:55], v[54:55], v[62:63]
    v_pk_fma_f32 v[184:185], v[48:49], v[200:201], v[184:185] op_sel_hi:[1,0,1]
    v_pk_fma_f32 v[186:187], v[50:51], v[200:201], v[186:187] op_sel_hi:[1,0,1]
    v_pk_fma_f32 v[188:189], v[52:53], v[200:201], v[188:189] op_sel_hi:[1,0,1]
    v_pk_fma_f32 v[190:191], v[54:55], v[200:201], v[190:191] op_sel_hi:[1,0,1]
    v_cvt_pk_bf16_f32 v32, v184, v185
    v_cvt_pk_bf16_f32 v33, v186, v187
    v_cvt_pk_bf16_f32 v34, v188, v189
    v_cvt_pk_bf16_f32 v35, v190, v191
    buffer_store_dwordx4 v[32:35], v224, s[12:15], s31 offen sc0 sc1
    s_waitcnt lgkmcnt(0)
    v_pk_add_f32 v[64:65], v[64:65], v[72:73]
    v_pk_add_f32 v[66:67], v[66:67], v[74:75]
    v_pk_add_f32 v[68:69], v[68:69], v[76:77]
    v_pk_add_f32 v[70:71], v[70:71], v[78:79]
    v_pk_fma_f32 v[192:193], v[64:65], v[200:201], v[192:193] op_sel:[0,1,0] op_sel_hi:[1,1,1]
    v_pk_fma_f32 v[194:195], v[66:67], v[200:201], v[194:195] op_sel:[0,1,0] op_sel_hi:[1,1,1]
    v_pk_fma_f32 v[196:197], v[68:69], v[200:201], v[196:197] op_sel:[0,1,0] op_sel_hi:[1,1,1]
    v_pk_fma_f32 v[198:199], v[70:71], v[200:201], v[198:199] op_sel:[0,1,0] op_sel_hi:[1,1,1]
    v_cvt_pk_bf16_f32 v36, v192, v193
    v_cvt_pk_bf16_f32 v37, v194, v195
    v_cvt_pk_bf16_f32 v38, v196, v197
    v_cvt_pk_bf16_f32 v39, v198, v199
    buffer_store_dwordx4 v[36:39], v224, s[12:15], s89 offen sc0 sc1
L_end:
    s_endpgm
P3_y0:
    v_not_b32 v3, v3
    v_or_b32 v3, 0x80000000, v3
    v_xor_b32 v3, v3, v214
    v_and_b32 v3, 0xffff0000, v3
    v_mul_f32 v3, 0xbfb8aa3b, v3
    v_exp_f32 v3, v3
    v_and_b32 v12, 15, v1
    v_add_f32 v3, 1.0, v3
    v_rcp_f32 v3, v3
    s_mul_i32 s47, s26, 512
    v_cvt_pk_bf16_f32 v3, v3, v3
    v_and_b32 v14, 0xffff0000, v3
    s_add_u32 s47, s47, 159744
    v_lshrrev_b32 v10, 4, v1
    v_mul_u32_u24 v10, 1792, v10
    v_lshl_add_u32 v10, v12, 3, v10
    v_lshl_add_u32 v12, v12, 3, s47
    v_lshl_add_u32 v13, v213, 5, s47
    s_lshl_b32 s45, s31, 1
    s_add_u32 s45, s45, 229376
    s_ff1_i32_b32 s46, s44
    s_mul_i32 s47, s46, 50176
    s_add_u32 s72, s47, s45
    s_add_u32 s73, s72, 7168
    s_add_u32 s74, s72, 14336
    s_add_u32 s75, s72, 21504
    s_add_u32 s76, s72, 28672
    s_add_u32 s77, s72, 35840
    s_add_u32 s78, s72, 43008
    s_bitset0_b32 s44, s46
    s_ff1_i32_b32 s48, s44
    s_bitset1_b32 s44, s46
    s_mul_i32 s47, s48, 50176
    s_add_u32 s79, s47, s45
    s_add_u32 s80, s79, 7168
    s_add_u32 s81, s79, 14336
    s_add_u32 s82, s79, 21504
    s_add_u32 s83, s79, 28672
    s_add_u32 s84, s79, 35840
    s_add_u32 s85, s79, 43008
    s_branch P3_y0d
P3_ya:
    v_mfma_f32_32x32x16_bf16 v[128:143], a[116:119], a[184:187], v[128:143]
    buffer_load_dwordx2 v[144:145], v10, s[16:19], s72 offen sc1
    buffer_load_dwordx2 v[146:147], v10, s[16:19], s73 offen sc1
    buffer_load_dwordx2 v[148:149], v10, s[16:19], s74 offen sc1
    buffer_load_dwordx2 v[150:151], v10, s[16:19], s75 offen sc1
    v_mfma_f32_32x32x16_bf16 v[112:127], a[112:115], a[184:187], v[112:127]
    buffer_load_dwordx2 v[152:153], v10, s[16:19], s76 offen sc1
    buffer_load_dwordx2 v[154:155], v10, s[16:19], s77 offen sc1
    buffer_load_dwordx2 v[156:157], v10, s[16:19], s78 offen sc1
    v_mfma_f32_32x32x16_bf16 v[128:143], a[124:127], a[188:191], v[128:143]
    v_mfma_f32_32x32x16_bf16 v[112:127], a[120:123], a[188:191], v[112:127]
    buffer_store_dwordx2 v[220:221], v222, s[16:19], s60 offen offset:0 sc1
    s_cmp_lt_i32 s48, 0
    s_nop 7
    s_cbranch_scc1 P3_yad
    buffer_load_dwordx2 v[160:161], v10, s[16:19], s79 offen sc1
    buffer_load_dwordx2 v[162:163], v10, s[16:19], s80 offen sc1
    buffer_load_dwordx2 v[164:165], v10, s[16:19], s81 offen sc1
    buffer_load_dwordx2 v[166:167], v10, s[16:19], s82 offen sc1
    buffer_load_dwordx2 v[168:169], v10, s[16:19], s83 offen sc1
    buffer_load_dwordx2 v[170:171], v10, s[16:19], s84 offen sc1
    buffer_load_dwordx2 v[172:173], v10, s[16:19], s85 offen sc1
    s_branch P3_yad
P3_y:
P3_yz0:
    v_readlane_b32 s49, v14, s46
    v_readlane_b32 s51, v2, s46
    s_bitset0_b32 s44, s46
    s_mov_b32 s94, 64
    s_and_b32 s35, s51, 15
P3_yw0:
    s_waitcnt vmcnt(0)
    v_pk_add_f32 v[144:145], v[144:145], v[146:147]
    v_pk_add_f32 v[148:149], v[148:149], v[150:151]
    v_pk_add_f32 v[152:153], v[152:153], v[154:155]
    v_pk_add_f32 v[144:145], v[144:145], v[156:157]
    v_pk_add_f32 v[148:149], v[148:149], v[152:153]
    v_pk_add_f32 v[144:145], v[144:145], v[148:149]
    v_mov_b32 v146, v144
    v_mov_b32 v147, v145
    v_cmp_u_f32 vcc, v144, v145
    v_permlane32_swap_b32 v144, v146
    v_permlane32_swap_b32 v145, v147
    s_cmp_lg_u64 vcc, 0
    s_cbranch_scc1 P3_yre0
P3_yok0:
    v_pk_add_f32 v[144:145], v[144:145], v[146:147]
    v_mov_b32 v146, v144
    v_mov_b32 v147, v145
    v_cmp_eq_u32 s[56:57], s35, v211
    v_permlane16_swap_b32 v144, v146
    v_permlane16_swap_b32 v145, v147
    s_nop 1
    v_pk_add_f32 v[144:145], v[144:145], v[146:147]
    v_mul_f32 v144, s49, v144
    v_mul_f32 v145, s49, v145
    ds_write_b64 v12, v[144:145]
    ds_read_b128 v[144:147], v13
    ds_read_b128 v[148:151], v13 offset:16
    s_bitcmp1_b32 s51, 4
    s_mov_b64 exec, s[56:57]
    s_waitcnt lgkmcnt(0)
    s_cbranch_scc1 P3_yhi0
    v_pk_fma_f32 v[184:185], v[144:145], v[202:203], v[184:185] op_sel_hi:[1,0,1]
    v_pk_fma_f32 v[186:187], v[146:147], v[202:203], v[186:187] op_sel_hi:[1,0,1]
    v_pk_fma_f32 v[188:189], v[148:149], v[202:203], v[188:189] op_sel_hi:[1,0,1]
    v_pk_fma_f32 v[190:191], v[150:151], v[202:203], v[190:191] op_sel_hi:[1,0,1]
    s_mov_b64 exec, -1
    s_cmp_eq_u32 s44, 0
    s_cbranch_scc1 P3_yd
    s_branch P3_yz1
P3_yhi0:
    v_pk_fma_f32 v[192:193], v[144:145], v[202:203], v[192:193] op_sel:[0,1,0] op_sel_hi:[1,1,1]
    v_pk_fma_f32 v[194:195], v[146:147], v[202:203], v[194:195] op_sel:[0,1,0] op_sel_hi:[1,1,1]
    v_pk_fma_f32 v[196:197], v[148:149], v[202:203], v[196:197] op_sel:[0,1,0] op_sel_hi:[1,1,1]
    v_pk_fma_f32 v[198:199], v[150:151], v[202:203], v[198:199] op_sel:[0,1,0] op_sel_hi:[1,1,1]
    s_mov_b64 exec, -1
    s_cmp_eq_u32 s44, 0
    s_cbranch_scc1 P3_yd
    s_branch P3_yz1
P3_yz1:
    v_readlane_b32 s49, v14, s48
    v_readlane_b32 s51, v2, s48
    s_bitset0_b32 s44, s48
    s_mov_b32 s94, 64
    s_and_b32 s35, s51, 15
P3_yw1:
    s_waitcnt vmcnt(0)
    v_pk_add_f32 v[160:161], v[160:161], v[162:163]
    v_pk_add_f32 v[164:165], v[164:165], v[166:167]
    v_pk_add_f32 v[168:169], v[168:169], v[170:171]
    v_pk_add_f32 v[160:161], v[160:161], v[172:173]
    v_pk_add_f32 v[164:165], v[164:165], v[168:169]
    v_pk_add_f32 v[160:161], v[160:161], v[164:165]
    v_mov_b32 v162, v160
    v_mov_b32 v163, v161
    v_cmp_u_f32 vcc, v160, v161
    v_permlane32_swap_b32 v160, v162
    v_permlane32_swap_b32 v161, v163
    s_cmp_lg_u64 vcc, 0
    s_cbranch_scc1 P3_yre1
P3_yok1:
    v_pk_add_f32 v[160:161], v[160:161], v[162:163]
    v_mov_b32 v162, v160
    v_mov_b32 v163, v161
    v_cmp_eq_u32 s[56:57], s35, v211
    v_permlane16_swap_b32 v160, v162
    v_permlane16_swap_b32 v161, v163
    s_nop 1
    v_pk_add_f32 v[160:161], v[160:161], v[162:163]
    v_mul_f32 v160, s49, v160
    v_mul_f32 v161, s49, v161
    ds_write_b64 v12, v[160:161]
    ds_read_b128 v[160:163], v13
    ds_read_b128 v[164:167], v13 offset:16
    s_bitcmp1_b32 s51, 4
    s_mov_b64 exec, s[56:57]
    s_waitcnt lgkmcnt(0)
    s_cbranch_scc1 P3_yhi1
    v_pk_fma_f32 v[184:185], v[160:161], v[202:203], v[184:185] op_sel_hi:[1,0,1]
    v_pk_fma_f32 v[186:187], v[162:163], v[202:203], v[186:187] op_sel_hi:[1,0,1]
    v_pk_fma_f32 v[188:189], v[164:165], v[202:203], v[188:189] op_sel_hi:[1,0,1]
    v_pk_fma_f32 v[190:191], v[166:167], v[202:203], v[190:191] op_sel_hi:[1,0,1]
    s_mov_b64 exec, -1
    s_cmp_eq_u32 s44, 0
    s_cbranch_scc1 P3_yd
    s_branch P3_ymore
P3_yhi1:
    v_pk_fma_f32 v[192:193], v[160:161], v[202:203], v[192:193] op_sel:[0,1,0] op_sel_hi:[1,1,1]
    v_pk_fma_f32 v[194:195], v[162:163], v[202:203], v[194:195] op_sel:[0,1,0] op_sel_hi:[1,1,1]
    v_pk_fma_f32 v[196:197], v[164:165], v[202:203], v[196:197] op_sel:[0,1,0] op_sel_hi:[1,1,1]
    v_pk_fma_f32 v[198:199], v[166:167], v[202:203], v[198:199] op_sel:[0,1,0] op_sel_hi:[1,1,1]
    s_mov_b64 exec, -1
    s_cmp_eq_u32 s44, 0
    s_cbranch_scc1 P3_yd
    s_branch P3_ymore
P3_spare:
    s_cmp_ge_u32 s95, 28
    s_cbranch_scc1 P3_idle
P3_moe:
    ds_read_b64_tr_b16 a[64:65], v180 offset:0
    ds_read_b64_tr_b16 a[66:67], v180 offset:512
    ds_read_b64_tr_b16 a[68:69], v180 offset:4096
    ds_read_b64_tr_b16 a[70:71], v180 offset:4608
    ds_read_b64_tr_b16 a[72:73], v180 offset:8192
    ds_read_b64_tr_b16 a[74:75], v180 offset:8704
    ds_read_b64_tr_b16 a[76:77], v180 offset:12288
    ds_read_b64_tr_b16 a[78:79], v180 offset:12800
    ds_read_b64_tr_b16 a[80:81], v180 offset:16384
    ds_read_b64_tr_b16 a[82:83], v180 offset:16896
    ds_read_b64_tr_b16 a[84:85], v180 offset:20480
    ds_read_b64_tr_b16 a[86:87], v180 offset:20992
    ds_read_b64_tr_b16 a[88:89], v180 offset:24576
    ds_read_b64_tr_b16 a[90:91], v180 offset:25088
    s_waitcnt lgkmcnt(12)
    v_mfma_f32_16x16x32_bf16 v[16:19], a[64:67], a[0:3], 0
    ds_read_b64_tr_b16 a[92:93], v180 offset:28672
    ds_read_b64_tr_b16 a[94:95], v180 offset:29184
    s_waitcnt lgkmcnt(12)
    v_mfma_f32_16x16x32_bf16 v[16:19], a[68:71], a[4:7], v[16:19]
    ds_read_b64_tr_b16 a[96:97], v180 offset:32768
    ds_read_b64_tr_b16 a[98:99], v180 offset:33280
    s_waitcnt lgkmcnt(12)
    v_mfma_f32_16x16x32_bf16 v[16:19], a[72:75], a[8:11], v[16:19]
    ds_read_b64_tr_b16 a[100:101], v180 offset:36864
    ds_read_b64_tr_b16 a[102:103], v180 offset:37376
    s_waitcnt lgkmcnt(12)
    v_mfma_f32_16x16x32_bf16 v[16:19], a[76:79], a[12:15], v[16:19]
    ds_read_b64_tr_b16 a[104:105], v180 offset:40960
    ds_read_b64_tr_b16 a[106:107], v180 offset:41472
    s_waitcnt lgkmcnt(12)
    v_mfma_f32_16x16x32_bf16 v[16:19], a[80:83], a[16:19], v[16:19]
    ds_read_b64_tr_b16 a[108:109], v180 offset:45056
    ds_read_b64_tr_b16 a[110:111], v180 offset:45568
    s_waitcnt lgkmcnt(12)
    v_mfma_f32_16x16x32_bf16 v[16:19], a[84:87], a[20:23], v[16:19]
    ds_read_b64_tr_b16 a[112:113], v180 offset:49152
    ds_read_b64_tr_b16 a[114:115], v180 offset:49664
    s_waitcnt lgkmcnt(12)
    v_mfma_f32_16x16x32_bf16 v[16:19], a[88:91], a[24:27], v[16:19]
    ds_read_b64_tr_b16 a[116:117], v180 offset:53248
    ds_read_b64_tr_b16 a[118:119], v180 offset:53760
    s_waitcnt lgkmcnt(12)
    v_mfma_f32_16x16x32_bf16 v[16:19], a[92:95], a[28:31], v[16:19]
    ds_read_b64_tr_b16 v[48:49], v184 offset:0
    ds_read_b64_tr_b16 v[50:51], v184 offset:3584
    s_waitcnt lgkmcnt(12)
    v_mfma_f32_16x16x32_bf16 v[16:19], a[96:99], a[32:35], v[16:19]
    ds_read_b64_tr_b16 v[52:53], v184 offset:28672
    ds_read_b64_tr_b16 v[54:55], v184 offset:32256
    s_waitcnt lgkmcnt(12)
    v_mfma_f32_16x16x32_bf16 v[16:19], a[100:103], a[36:39], v[16:19]
    ds_read_b64_tr_b16 v[56:57], v185 offset:0
    ds_read_b64_tr_b16 v[58:59], v185 offset:3584
    s_waitcnt lgkmcnt(12)
    v_mfma_f32_16x16x32_bf16 v[16:19], a[104:107], a[40:43], v[16:19]
    ds_read_b64_tr_b16 v[60:61], v185 offset:28672
    ds_read_b64_tr_b16 v[62:63], v185 offset:32256
    s_waitcnt lgkmcnt(12)
    v_mfma_f32_16x16x32_bf16 v[16:19], a[108:111], a[44:47], v[16:19]
    ds_read_b64_tr_b16 v[64:65], v186 offset:0
    ds_read_b64_tr_b16 v[66:67], v186 offset:3584
    s_waitcnt lgkmcnt(12)
    v_mfma_f32_16x16x32_bf16 v[16:19], a[112:115], a[48:51], v[16:19]
    ds_read_b64_tr_b16 v[68:69], v186 offset:28672
    ds_read_b64_tr_b16 v[70:71], v186 offset:32256
    s_waitcnt lgkmcnt(12)
    v_mfma_f32_16x16x32_bf16 v[16:19], a[116:119], a[52:55], v[16:19]
    s_waitcnt lgkmcnt(6)
    ds_read_b64_tr_b16 v[72:73], v187 offset:0
    ds_read_b64_tr_b16 v[74:75], v187 offset:3584
    ds_read_b64_tr_b16 v[76:77], v187 offset:28672
    ds_read_b64_tr_b16 v[78:79], v187 offset:32256
    ds_read_b64_tr_b16 v[80:81], v188 offset:0
    ds_read_b64_tr_b16 v[82:83], v188 offset:3584
    ds_read_b64_tr_b16 v[84:85], v188 offset:28672
    v_pk_mul_f32 v[16:17], v[16:17], v[176:177]
    v_pk_mul_f32 v[18:19], v[18:19], v[178:179]
    v_cvt_pk_bf16_f32 v16, v16, v17
    v_cvt_pk_bf16_f32 v17, v18, v19
    ds_write_b64 v181, v[16:17]
    s_waitcnt lgkmcnt(0)
    s_barrier
    ds_read_b128 v[24:27], v182
    ds_read_b128 v[28:31], v182 offset:24576
    ds_read_b64_tr_b16 v[86:87], v188 offset:32256
    ds_read_b64_tr_b16 v[88:89], v189 offset:0
    ds_read_b64_tr_b16 v[90:91], v189 offset:3584
    ds_read_b64_tr_b16 v[92:93], v189 offset:28672
    ds_read_b64_tr_b16 v[94:95], v189 offset:32256
    ds_read_b64_tr_b16 v[96:97], v190 offset:0
    ds_read_b64_tr_b16 v[98:99], v190 offset:3584
    ds_read_b64_tr_b16 v[100:101], v190 offset:28672
    ds_read_b64_tr_b16 v[102:103], v190 offset:32256
    s_waitcnt lgkmcnt(9)
    v_mfma_f32_16x16x32_bf16 v[120:123], v[48:51], v[24:27], 0
    v_mfma_f32_16x16x32_bf16 v[120:123], v[52:55], v[28:31], v[120:123]
    v_mfma_f32_16x16x32_bf16 v[124:127], v[56:59], v[24:27], 0
    v_mfma_f32_16x16x32_bf16 v[124:127], v[60:63], v[28:31], v[124:127]
    v_mfma_f32_16x16x32_bf16 v[128:131], v[64:67], v[24:27], 0
    v_mfma_f32_16x16x32_bf16 v[128:131], v[68:71], v[28:31], v[128:131]
    v_mfma_f32_16x16x32_bf16 v[132:135], v[72:75], v[24:27], 0
    v_mfma_f32_16x16x32_bf16 v[132:135], v[76:79], v[28:31], v[132:135]
    s_waitcnt lgkmcnt(0)
    v_mfma_f32_16x16x32_bf16 v[136:139], v[80:83], v[24:27], 0
    v_mfma_f32_16x16x32_bf16 v[136:139], v[84:87], v[28:31], v[136:139]
    ds_write_b128 v206, v[120:123] offset:0
    v_mfma_f32_16x16x32_bf16 v[140:143], v[88:91], v[24:27], 0
    v_mfma_f32_16x16x32_bf16 v[140:143], v[92:95], v[28:31], v[140:143]
    ds_write_b128 v206, v[124:127] offset:64
    v_mfma_f32_16x16x32_bf16 v[144:147], v[96:99], v[24:27], 0
    v_mfma_f32_16x16x32_bf16 v[144:147], v[100:103], v[28:31], v[144:147]
    ds_write_b128 v206, v[128:131] offset:128
    ds_write_b128 v206, v[132:135] offset:192
    ds_write_b128 v206, v[136:139] offset:256
    s_nop 2
    ds_write_b128 v206, v[140:143] offset:320
    s_nop 2
    ds_write_b128 v206, v[144:147] offset:384
    ds_read_b128 v[48:51], v207
    ds_read_b128 v[52:55], v208
    ds_read_b128 v[56:59], v209
    ds_read_b128 v[60:63], v210
    s_waitcnt lgkmcnt(3)
    buffer_store_dwordx4 v[48:51], v183, s[16:19], s27 offen sc1
    s_waitcnt lgkmcnt(2)
    buffer_store_dwordx4 v[52:55], v191, s[16:19], s27 offen sc1
    s_waitcnt lgkmcnt(1)
    buffer_store_dwordx4 v[56:59], v224, s[16:19], s27 offen sc1
    s_waitcnt lgkmcnt(0)
    buffer_store_dwordx4 v[60:63], v237, s[16:19], s27 offen sc1
    s_waitcnt vmcnt(4)
    buffer_store_dwordx2 v[220:221], v222, s[16:19], s60 offen offset:0 sc1
    s_waitcnt vmcnt(0)
    buffer_store_dwordx2 v[220:221], v222, s[16:19], s60 offen offset:32 sc1
    s_endpgm
P2_dn0:
    s_add_u32 m0, s25, 0
    s_add_u32 s37, s24, 0
    buffer_load_dwordx4 v192, s[12:15], s37 offen offset:0 lds
    buffer_load_dwordx4 v193, s[12:15], s37 offen offset:1024 lds
    buffer_load_dwordx4 v194, s[12:15], s37 offen offset:2048 lds
    buffer_load_dwordx4 v195, s[12:15], s37 offen offset:3072 lds
    s_add_u32 m0, s25, 4096
    s_add_u32 s37, s24, 4096
    buffer_load_dwordx4 v196, s[12:15], s37 offen offset:0 lds
    buffer_load_dwordx4 v197, s[12:15], s37 offen offset:1024 lds
    buffer_load_dwordx4 v198, s[12:15], s37 offen offset:2048 lds
    buffer_load_dwordx4 v199, s[12:15], s37 offen offset:3072 lds
    s_cmp_lt_u32 s95, 28
    s_branch P2_dn0d
P2_dn1:
    s_add_u32 m0, s25, 8192
    s_add_u32 s37, s24, 8192
    buffer_load_dwordx4 v200, s[12:15], s37 offen offset:0 lds
    buffer_load_dwordx4 v201, s[12:15], s37 offen offset:1024 lds
    buffer_load_dwordx4 v202, s[12:15], s37 offen offset:2048 lds
    buffer_load_dwordx4 v203, s[12:15], s37 offen offset:3072 lds
    s_add_u32 m0, s25, 12288
    s_add_u32 s37, s24, 12288
    buffer_load_dwordx4 v204, s[12:15], s37 offen offset:0 lds
    buffer_load_dwordx4 v205, s[12:15], s37 offen offset:1024 lds
    s_branch P2_dn1d
P3_idle:
    s_waitcnt vmcnt(0)
    buffer_store_dwordx2 v[220:221], v222, s[16:19], s60 offen offset:0 sc1
    s_cmp_lg_u32 s2, 255
    s_cbranch_scc1 L_end2
    v_lshrrev_b32 v2, 4, v1
    s_lshl_b32 s38, s26, 2
    v_add_u32 v2, s38, v2
    v_lshlrev_b32 v2, 6, v2
    v_and_b32 v3, 15, v1
    v_add_u32 v2, v2, v3
    v_lshlrev_b32 v10, 7, v2
    s_mov_b32 s38, 65600
    s_mov_b32 s94, 131072
P3_epoll:
    buffer_load_dwordx2 v[6:7], v10, s[16:19], s38 offen sc1
    s_sub_u32 s94, s94, 1
    s_waitcnt vmcnt(0)
    v_cmp_ne_u64 vcc, s[68:69], v[6:7]
    s_cmp_eq_u32 s94, 0
    s_cbranch_scc1 P3_epoll_d
    s_cmp_lg_u64 vcc, 0
    s_cbranch_scc1 P3_epoll
P3_epoll_d:
    s_barrier
    s_cmp_lg_u32 s26, 0
    s_cbranch_scc1 L_end2
    buffer_store_dwordx2 v[220:221], v222, s[16:19], 0 offen offset:0 sc1
L_end2:
    s_endpgm
P3_yre0:
    s_cmp_eq_u32 s94, 0
    s_cbranch_scc1 P3_yok0
    s_sub_u32 s94, s94, 1
    s_cmp_lg_u32 s94, 0
    s_cbranch_scc1 P3_yrl0
    s_mov_b32 exec_lo, 0xffffff00
    s_movk_i32 s37, 32
    s_mov_b32 s94, 131072
P3_yfl0:
    buffer_load_dwordx2 v[6:7], v244, s[16:19], s37 offen sc1
    s_sub_u32 s94, s94, 1
    s_waitcnt vmcnt(0)
    v_cmp_ne_u64 vcc, s[68:69], v[6:7]
    s_cmp_eq_u32 s94, 0
    s_cbranch_scc1 P3_yfl0_d
    s_cmp_lg_u64 vcc, 0
    s_cbranch_scc1 P3_yfl0
P3_yfl0_d:
    s_mov_b64 exec, -1
    s_mov_b32 s94, 0
P3_yrl0:
    buffer_load_dwordx2 v[144:145], v10, s[16:19], s72 offen sc1
    buffer_load_dwordx2 v[146:147], v10, s[16:19], s73 offen sc1
    buffer_load_dwordx2 v[148:149], v10, s[16:19], s74 offen sc1
    buffer_load_dwordx2 v[150:151], v10, s[16:19], s75 offen sc1
    buffer_load_dwordx2 v[152:153], v10, s[16:19], s76 offen sc1
    buffer_load_dwordx2 v[154:155], v10, s[16:19], s77 offen sc1
    buffer_load_dwordx2 v[156:157], v10, s[16:19], s78 offen sc1
    s_cmp_lt_i32 s48, 0
    s_cbranch_scc1 P3_yw0
    buffer_load_dwordx2 v[160:161], v10, s[16:19], s79 offen sc1
    buffer_load_dwordx2 v[162:163], v10, s[16:19], s80 offen sc1
    buffer_load_dwordx2 v[164:165], v10, s[16:19], s81 offen sc1
    buffer_load_dwordx2 v[166:167], v10, s[16:19], s82 offen sc1
    buffer_load_dwordx2 v[168:169], v10, s[16:19], s83 offen sc1
    buffer_load_dwordx2 v[170:171], v10, s[16:19], s84 offen sc1
    buffer_load_dwordx2 v[172:173], v10, s[16:19], s85 offen sc1
    s_branch P3_yw0
P3_yre1:
    s_cmp_eq_u32 s94, 0
    s_cbranch_scc1 P3_yok1
    s_sub_u32 s94, s94, 1
    s_cmp_lg_u32 s94, 0
    s_cbranch_scc1 P3_yrl1
    s_mov_b32 exec_lo, 0xffffff00
    s_movk_i32 s37, 32
    s_mov_b32 s94, 131072
P3_yfl1:
    buffer_load_dwordx2 v[6:7], v244, s[16:19], s37 offen sc1
    s_sub_u32 s94, s94, 1
    s_waitcnt vmcnt(0)
    v_cmp_ne_u64 vcc, s[68:69], v[6:7]
    s_cmp_eq_u32 s94, 0
    s_cbranch_scc1 P3_yfl1_d
    s_cmp_lg_u64 vcc, 0
    s_cbranch_scc1 P3_yfl1
P3_yfl1_d:
    s_mov_b64 exec, -1
    s_mov_b32 s94, 0
P3_yrl1:
    buffer_load_dwordx2 v[160:161], v10, s[16:19], s79 offen sc1
    buffer_load_dwordx2 v[162:163], v10, s[16:19], s80 offen sc1
    buffer_load_dwordx2 v[164:165], v10, s[16:19], s81 offen sc1
    buffer_load_dwordx2 v[166:167], v10, s[16:19], s82 offen sc1
    buffer_load_dwordx2 v[168:169], v10, s[16:19], s83 offen sc1
    buffer_load_dwordx2 v[170:171], v10, s[16:19], s84 offen sc1
    buffer_load_dwordx2 v[172:173], v10, s[16:19], s85 offen sc1
    s_branch P3_yw1
P3_r0:
    s_cmp_eq_u32 s40, 0
    s_cbranch_scc1 P3_kd0
    s_sub_u32 s40, s40, 1
    buffer_load_dwordx4 a[128:131], v240, s[16:19], s24 offen offset:0 sc1
    buffer_load_dwordx4 a[132:135], v240, s[16:19], s24 offen offset:1024 sc1
    s_waitcnt vmcnt(0)
    v_accvgpr_read_b32 v4, a128
    v_accvgpr_read_b32 v5, a132
    v_max_u32 v4, v4, v5
    v_cmp_eq_u32 vcc, -1, v4
    s_nop 1
    s_cmp_lg_u64 vcc, 0
    s_cbranch_scc1 P3_r0
    s_branch P3_kd0
P3_r1:
    s_cmp_eq_u32 s40, 0
    s_cbranch_scc1 P3_kd1
    s_sub_u32 s40, s40, 1
    buffer_load_dwordx4 a[136:139], v240, s[16:19], s24 offen offset:2048 sc1
    buffer_load_dwordx4 a[140:143], v240, s[16:19], s24 offen offset:3072 sc1
    s_waitcnt vmcnt(0)
    v_accvgpr_read_b32 v4, a136
    v_accvgpr_read_b32 v5, a140
    v_max_u32 v4, v4, v5
    v_cmp_eq_u32 vcc, -1, v4
    s_nop 1
    s_cmp_lg_u64 vcc, 0
    s_cbranch_scc1 P3_r1
    s_branch P3_kd1
P3_r2:
    s_cmp_eq_u32 s40, 0
    s_cbranch_scc1 P3_kd2
    s_sub_u32 s40, s40, 1
    buffer_load_dwordx4 a[144:147], v240, s[16:19], s25 offen offset:0 sc1
    buffer_load_dwordx4 a[148:151], v240, s[16:19], s25 offen offset:1024 sc1
    s_waitcnt vmcnt(0)
    v_accvgpr_read_b32 v4, a144
    v_accvgpr_read_b32 v5, a148
    v_max_u32 v4, v4, v5
    v_cmp_eq_u32 vcc, -1, v4
    s_nop 1
    s_cmp_lg_u64 vcc, 0
    s_cbranch_scc1 P3_r2
    s_branch P3_kd2
P3_r3:
    s_cmp_eq_u32 s40, 0
    s_cbranch_scc1 P3_kd3
    s_sub_u32 s40, s40, 1
    buffer_load_dwordx4 a[152:155], v240, s[16:19], s25 offen offset:2048 sc1
    buffer_load_dwordx4 a[156:159], v240, s[16:19], s25 offen offset:3072 sc1
    s_waitcnt vmcnt(0)
    v_accvgpr_read_b32 v4, a152
    v_accvgpr_read_b32 v5, a156
    v_max_u32 v4, v4, v5
    v_cmp_eq_u32 vcc, -1, v4
    s_nop 1
    s_cmp_lg_u64 vcc, 0
    s_cbranch_scc1 P3_r3
    s_branch P3_kd3
P3_r4:
    s_cmp_eq_u32 s40, 0
    s_cbranch_scc1 P3_kd4
    s_sub_u32 s40, s40, 1
    buffer_load_dwordx4 a[160:163], v240, s[16:19], s27 offen offset:0 sc1
    buffer_load_dwordx4 a[164:167], v240, s[16:19], s27 offen offset:1024 sc1
    s_waitcnt vmcnt(0)
    v_accvgpr_read_b32 v4, a160
    v_accvgpr_read_b32 v5, a164
    v_max_u32 v4, v4, v5
    v_cmp_eq_u32 vcc, -1, v4
    s_nop 1
    s_cmp_lg_u64 vcc, 0
    s_cbranch_scc1 P3_r4
    s_branch P3_kd4
P3_r5:
    s_cmp_eq_u32 s40, 0
    s_cbranch_scc1 P3_kd5
    s_sub_u32 s40, s40, 1
    buffer_load_dwordx4 a[168:171], v240, s[16:19], s27 offen offset:2048 sc1
    buffer_load_dwordx4 a[172:175], v240, s[16:19], s27 offen offset:3072 sc1
    s_waitcnt vmcnt(0)
    v_accvgpr_read_b32 v4, a168
    v_accvgpr_read_b32 v5, a172
    v_max_u32 v4, v4, v5
    v_cmp_eq_u32 vcc, -1, v4
    s_nop 1
    s_cmp_lg_u64 vcc, 0
    s_cbranch_scc1 P3_r5
    s_branch P3_kd5
P3_r6:
    s_cmp_eq_u32 s40, 0
    s_cbranch_scc1 P3_kd6
    s_sub_u32 s40, s40, 1
    buffer_load_dwordx4 a[176:179], v240, s[16:19], s50 offen offset:0 sc1
    buffer_load_dwordx4 a[180:183], v240, s[16:19], s50 offen offset:1024 sc1
    buffer_load_dwordx4 a[184:187], v240, s[16:19], s50 offen offset:2048 sc1
    buffer_load_dwordx4 a[188:191], v240, s[16:19], s50 offen offset:3072 sc1
    s_waitcnt vmcnt(0)
    v_accvgpr_read_b32 v4, a176
    v_accvgpr_read_b32 v5, a180
    v_max_u32 v4, v4, v5
    v_cmp_eq_u32 vcc, -1, v4
    s_nop 1
    s_cmp_lg_u64 vcc, 0
    s_cbranch_scc1 P3_r6
    s_branch P3_kd6
P3_r7:
    s_cmp_eq_u32 s40, 0
    s_cbranch_scc1 P3_kd7
    s_sub_u32 s40, s40, 1
    buffer_load_dwordx4 a[184:187], v240, s[16:19], s50 offen offset:2048 sc1
    buffer_load_dwordx4 a[188:191], v240, s[16:19], s50 offen offset:3072 sc1
    s_waitcnt vmcnt(0)
    v_accvgpr_read_b32 v4, a184
    v_accvgpr_read_b32 v5, a188
    v_max_u32 v4, v4, v5
    v_cmp_eq_u32 vcc, -1, v4
    s_nop 1
    s_cmp_lg_u64 vcc, 0
    s_cbranch_scc1 P3_r7
    s_branch P3_kd7
P3_slow:
    s_cmp_eq_u32 s41, 0
    s_cbranch_scc1 P3_fin
    s_sub_u32 s41, s41, 1
    s_cmp_lg_u32 s41, 0
    s_waitcnt vmcnt(0) lgkmcnt(0)
    s_cbranch_scc1 P3_ld
    s_mov_b64 exec, 0xff
    s_mov_b32 s94, 131072
P3_spoll:
    buffer_load_dwordx2 v[6:7], v244, s[16:19], 0 offen sc1
    s_sub_u32 s94, s94, 1
    s_waitcnt vmcnt(0)
    v_cmp_ne_u64 vcc, s[68:69], v[6:7]
    s_cmp_eq_u32 s94, 0
    s_cbranch_scc1 P3_spoll_d
    s_cmp_lg_u64 vcc, 0
    s_cbranch_scc1 P3_spoll
P3_spoll_d:
    s_mov_b64 exec, -1
    s_branch P3_ld
L_spare:
    s_load_dwordx2 s[4:5], s[0:1], 32
    s_load_dwordx2 s[44:45], s[0:1], 64
    s_load_dwordx2 s[72:73], s[0:1], 40
    s_sub_u32 s28, s29, 28
    s_lshl_b32 s95, s34, 2
    s_add_u32 s95, s95, s28
    s_lshl_b32 s60, s95, 2
    s_add_u32 s60, s60, s26
    s_lshl_b32 s60, s60, 4
    s_mul_i32 s61, s60, 896
    s_add_u32 s62, s61, 7168
    v_lshrrev_b32 v12, 3, v1
    v_and_b32 v13, 7, v1
    v_mul_u32_u24 v4, 896, v12
    v_lshl_add_u32 v4, v13, 4, v4
    v_lshlrev_b32 v5, 4, v1
    s_lshl_b32 s63, s26, 11
    s_mov_b32 s6, 896
    s_mov_b32 s7, 0x20000
    s_mov_b32 s46, 896
    s_mov_b32 s47, 0x20000
    v_mul_u32_u24 v226, 3584, v12
    v_bfe_u32 v6, v1, 4, 1
    s_and_b32 s40, s26, 1
    s_lshl_b32 s40, s40, 2
    v_lshl_or_b32 v6, v6, 1, s40
    v_xor_b32 v6, v6, v13
    v_lshl_add_u32 v226, v6, 4, v226
    s_lshl_b32 s64, s26, 10
    s_add_u32 s64, s64, 49152
    s_mul_i32 s65, s26, 28672
    s_lshl_b32 s40, s95, 7
    s_add_u32 s65, s65, s40
    s_cmp_lt_u32 s95, 28
    s_cselect_b32 s74, 1605632, 0
    s_mov_b32 s75, 0x20000
    s_mov_b32 m0, s63
    s_waitcnt lgkmcnt(0)
    buffer_load_dwordx4 v5, s[4:7], 0 offen lds
    s_add_u32 m0, s63, 1024
    s_load_dwordx2 s[68:69], s[16:17], 0
    buffer_load_dwordx4 v5, s[44:47], 0 offen lds
    buffer_load_dwordx4 v[16:19], v4, s[8:11], s61 offen offset:0
    buffer_load_dwordx4 v[44:47], v4, s[8:11], s62 offen offset:0
    buffer_load_dwordx4 v[20:23], v4, s[8:11], s61 offen offset:128
    buffer_load_dwordx4 v[48:51], v4, s[8:11], s62 offen offset:128
    s_lshl_b32 s40, s95, 7
    s_add_u32 s40, s40, 3968
    s_lshl_b32 s41, s60, 3
    s_add_u32 s41, s41, 16384
    v_mov_b32 v2, 0x7fffffff
    s_cmp_eq_u32 s95, 28
    s_cselect_b32 s42, 0xff0000, 0
    s_cmp_eq_u32 s26, 1
    s_cselect_b32 exec_lo, s42, 0
    s_mov_b32 exec_hi, 0
    v_mov_b32 v2, v5
    s_cmp_eq_u32 s26, 0
    s_cselect_b32 exec_lo, 0xffff, 0
    v_add_u32 v2, s40, v5
    s_mov_b64 exec, 0xff
    v_add_u32 v2, s41, v5
    s_mov_b64 exec, -1
    v_mov_b32 v136, -1
    v_mov_b32 v137, -1
    v_mov_b32 v138, -1
    v_mov_b32 v139, -1
    buffer_store_dwordx4 v[136:139], v2, s[16:19], 0 offen sc1
    buffer_load_dwordx4 v[24:27], v4, s[8:11], s61 offen offset:256
    buffer_load_dwordx4 v[52:55], v4, s[8:11], s62 offen offset:256
    buffer_load_dwordx4 v[28:31], v4, s[8:11], s61 offen offset:384
    buffer_load_dwordx4 v[56:59], v4, s[8:11], s62 offen offset:384
    buffer_load_dwordx4 v[32:35], v4, s[8:11], s61 offen offset:512
    buffer_load_dwordx4 v[60:63], v4, s[8:11], s62 offen offset:512
    buffer_load_dwordx4 v[36:39], v4, s[8:11], s61 offen offset:640
    buffer_load_dwordx4 v[64:67], v4, s[8:11], s62 offen offset:640
    buffer_load_dwordx4 v[40:43], v4, s[8:11], s61 offen offset:768
    buffer_load_dwordx4 v[68:71], v4, s[8:11], s62 offen offset:768
    s_add_u32 m0, s64, 0
    s_add_u32 s40, s65, 0
    buffer_load_dwordx4 v226, s[72:75], s40 offen lds
    s_add_u32 m0, s64, 4096
    s_add_u32 s40, s65, 114688
    buffer_load_dwordx4 v226, s[72:75], s40 offen lds
    s_add_u32 m0, s64, 8192
    s_add_u32 s40, s65, 229376
    buffer_load_dwordx4 v226, s[72:75], s40 offen lds
    s_lshr_b32 s100, s2, 4
    s_lshl_b32 s100, s100, 2
    s_add_u32 s100, s100, s26
    s_lshl_b32 s100, s100, 3
    s_and_b32 s101, s2, 7
    s_add_u32 s100, s100, s101
    s_lshl_b32 s100, s100, 1
    s_and_b32 s101, s29, 1
    s_add_u32 s100, s100, s101
    s_lshl_b32 s101, s100, 11
    s_add_u32 s101, s101, 7340032
    s_mov_b64 s[4:5], s[96:97]
    s_mov_b32 s6, s74
    s_mov_b64 s[12:13], s[98:99]
    s_mov_b32 s14, 1605632
    s_mov_b32 s70, 0
    s_mov_b32 s71, 0
    v_mov_b32 v224, 0
    v_mov_b32 v183, 0
    v_mov_b32 v191, 0
    v_mov_b32 v224, 0
    v_mov_b32 v237, 0
    v_mov_b32 v192, 0
    v_mov_b32 v193, 0
    v_mov_b32 v194, 0
    v_mov_b32 v195, 0
    v_mov_b32 v196, 0
    v_mov_b32 v197, 0
    v_mov_b32 v198, 0
    v_mov_b32 v199, 0
    v_mov_b32 v200, 0
    v_mov_b32 v201, 0
    v_mov_b32 v202, 0
    v_mov_b32 v203, 0
    v_mov_b32 v204, 0
    v_mov_b32 v205, 0
    v_mov_b32 v244, 0x7fffffff
    v_lshl_add_u32 v6, v13, 4, s63
    v_mov_b32 v8, 0
    v_mov_b32 v9, 0
    v_mov_b32 v10, 0
    v_mov_b32 v11, 0
    s_waitcnt vmcnt(17) lgkmcnt(0)
    ds_read_b128 v[72:75], v6 offset:0
    ds_read_b128 v[76:79], v6 offset:128
    ds_read_b128 v[80:83], v6 offset:256
    ds_read_b128 v[84:87], v6 offset:384
    ds_read_b128 v[88:91], v6 offset:512
    ds_read_b128 v[92:95], v6 offset:640
    ds_read_b128 v[96:99], v6 offset:768
    ds_read_b128 v[100:103], v6 offset:1024
    ds_read_b128 v[104:107], v6 offset:1152
    ds_read_b128 v[108:111], v6 offset:1280
    ds_read_b128 v[112:115], v6 offset:1408
    ds_read_b128 v[116:119], v6 offset:1536
    ds_read_b128 v[120:123], v6 offset:1664
    ds_read_b128 v[124:127], v6 offset:1792
    s_mul_i32 s68, s68, 1664525
    s_add_u32 s68, s68, 1013904223
    s_mul_i32 s69, s69, 22695477
    s_add_u32 s69, s69, 1
    v_and_b32 v2, 1, v1
    v_lshl_add_u32 v7, v2, 3, v12
    v_cmp_eq_u32 s[58:59], 1, v2
    v_add_u32 v14, s60, v7
    v_sub_u32 v15, 2047, v14
    s_lshl_b32 s66, s26, 6
    s_add_u32 s66, s66, 8192
    v_lshl_add_u32 v7, v7, 2, s66
    v_and_b32 v2, 15, v1
    v_lshl_add_u32 v128, v2, 2, s66
    v_lshrrev_b32 v2, 4, v1
    v_lshlrev_b32 v129, 6, v2
    v_lshlrev_b32 v130, 2, v1
    v_lshlrev_b32 v14, 3, v1
    v_mov_b32 v133, s68
    v_mov_b32 v131, 0
    s_lshl_b32 s67, s95, 7
    s_add_u32 s67, s67, 4096
    s_waitcnt lgkmcnt(0)
    s_waitcnt vmcnt(15)
    v_dot2c_f32_bf16 v8, v16, v72
    v_dot2c_f32_bf16 v9, v17, v73
    v_dot2c_f32_bf16 v10, v44, v72
    v_dot2c_f32_bf16 v11, v45, v73
    v_dot2c_f32_bf16 v8, v18, v74
    v_dot2c_f32_bf16 v9, v19, v75
    v_dot2c_f32_bf16 v10, v46, v74
    v_dot2c_f32_bf16 v11, v47, v75
    s_waitcnt vmcnt(13)
    v_dot2c_f32_bf16 v8, v20, v76
    v_dot2c_f32_bf16 v9, v21, v77
    v_dot2c_f32_bf16 v10, v48, v76
    v_dot2c_f32_bf16 v11, v49, v77
    v_dot2c_f32_bf16 v8, v22, v78
    v_dot2c_f32_bf16 v9, v23, v79
    v_dot2c_f32_bf16 v10, v50, v78
    v_dot2c_f32_bf16 v11, v51, v79
    s_waitcnt vmcnt(11)
    v_dot2c_f32_bf16 v8, v24, v80
    v_dot2c_f32_bf16 v9, v25, v81
    v_dot2c_f32_bf16 v10, v52, v80
    v_dot2c_f32_bf16 v11, v53, v81
    v_dot2c_f32_bf16 v8, v26, v82
    v_dot2c_f32_bf16 v9, v27, v83
    v_dot2c_f32_bf16 v10, v54, v82
    v_dot2c_f32_bf16 v11, v55, v83
    s_waitcnt vmcnt(9)
    v_dot2c_f32_bf16 v8, v28, v84
    v_dot2c_f32_bf16 v9, v29, v85
    v_dot2c_f32_bf16 v10, v56, v84
    v_dot2c_f32_bf16 v11, v57, v85
    v_dot2c_f32_bf16 v8, v30, v86
    v_dot2c_f32_bf16 v9, v31, v87
    v_dot2c_f32_bf16 v10, v58, v86
    v_dot2c_f32_bf16 v11, v59, v87
    s_add_u32 m0, s64, 12288
    s_add_u32 s40, s65, 344064
    buffer_load_dwordx4 v226, s[72:75], s40 offen lds
    s_waitcnt vmcnt(8)
    v_dot2c_f32_bf16 v8, v32, v88
    v_dot2c_f32_bf16 v9, v33, v89
    v_dot2c_f32_bf16 v10, v60, v88
    v_dot2c_f32_bf16 v11, v61, v89
    v_dot2c_f32_bf16 v8, v34, v90
    v_dot2c_f32_bf16 v9, v35, v91
    v_dot2c_f32_bf16 v10, v62, v90
    v_dot2c_f32_bf16 v11, v63, v91
    s_add_u32 m0, s64, 16384
    s_add_u32 s40, s65, 458752
    buffer_load_dwordx4 v226, s[72:75], s40 offen lds
    s_waitcnt vmcnt(7)
    v_dot2c_f32_bf16 v8, v36, v92
    v_dot2c_f32_bf16 v9, v37, v93
    v_dot2c_f32_bf16 v10, v64, v92
    v_dot2c_f32_bf16 v11, v65, v93
    v_dot2c_f32_bf16 v8, v38, v94
    v_dot2c_f32_bf16 v9, v39, v95
    v_dot2c_f32_bf16 v10, v66, v94
    v_dot2c_f32_bf16 v11, v67, v95
    s_add_u32 m0, s64, 20480
    s_add_u32 s40, s65, 573440
    buffer_load_dwordx4 v226, s[72:75], s40 offen lds
    s_waitcnt vmcnt(6)
    v_dot2c_f32_bf16 v8, v40, v96
    v_dot2c_f32_bf16 v9, v41, v97
    v_dot2c_f32_bf16 v10, v68, v96
    v_dot2c_f32_bf16 v11, v69, v97
    v_dot2c_f32_bf16 v8, v42, v98
    v_dot2c_f32_bf16 v9, v43, v99
    v_dot2c_f32_bf16 v10, v70, v98
    v_dot2c_f32_bf16 v11, v71, v99
    s_add_u32 m0, s64, 24576
    s_add_u32 s40, s65, 688128
    buffer_load_dwordx4 v226, s[72:75], s40 offen lds
    s_nop 2
    v_add_f32 v8, v8, v9
    v_add_f32 v10, v10, v11
    s_nop 0
    v_add_f32_dpp v8, v8, v8 quad_perm:[1,0,3,2] row_mask:0xf bank_mask:0xf
    v_add_f32_dpp v10, v10, v10 quad_perm:[1,0,3,2] row_mask:0xf bank_mask:0xf
    s_nop 0
    v_add_f32_dpp v8, v8, v8 quad_perm:[2,3,0,1] row_mask:0xf bank_mask:0xf
    v_add_f32_dpp v10, v10, v10 quad_perm:[2,3,0,1] row_mask:0xf bank_mask:0xf
    s_nop 0
    v_add_f32_dpp v8, v8, v8 row_half_mirror row_mask:0xf bank_mask:0xf
    v_add_f32_dpp v10, v10, v10 row_half_mirror row_mask:0xf bank_mask:0xf
    s_nop 0
    v_cndmask_b32 v8, v8, v10, s[58:59]
    v_cvt_pk_bf16_f32 v8, v8, v8
    v_ashrrev_i32 v2, 31, v8
    v_or_b32 v2, 0x80000000, v2
    v_xor_b32 v8, v8, v2
    v_and_b32 v8, 0xffff0000, v8
    v_or_b32 v8, v8, v15
    ds_write_b32 v7, v8
    s_add_u32 m0, s64, 28672
    s_add_u32 s40, s65, 802816
    buffer_load_dwordx4 v226, s[72:75], s40 offen lds
    s_waitcnt lgkmcnt(0)
    s_barrier
    ds_read_b32 v132, v128
    ds_read_b128 v[72:75], v129 offset:8192
    ds_read_b128 v[76:79], v129 offset:8208
    ds_read_b128 v[80:83], v129 offset:8224
    ds_read_b128 v[84:87], v129 offset:8240
    s_add_u32 m0, s64, 32768
    s_add_u32 s40, s65, 917504
    buffer_load_dwordx4 v226, s[72:75], s40 offen lds
    s_waitcnt lgkmcnt(0)
    v_cmp_gt_u32 s[48:49], v72, v132
    v_cmp_gt_u32 s[50:51], v73, v132
    v_cmp_gt_u32 s[52:53], v74, v132
    v_addc_co_u32 v131, s[56:57], 0, v131, s[48:49]
    v_cmp_gt_u32 s[54:55], v75, v132
    v_addc_co_u32 v131, s[56:57], 0, v131, s[50:51]
    v_cmp_gt_u32 s[48:49], v76, v132
    v_addc_co_u32 v131, s[56:57], 0, v131, s[52:53]
    v_cmp_gt_u32 s[50:51], v77, v132
    v_addc_co_u32 v131, s[56:57], 0, v131, s[54:55]
    v_cmp_gt_u32 s[52:53], v78, v132
    v_addc_co_u32 v131, s[56:57], 0, v131, s[48:49]
    v_cmp_gt_u32 s[54:55], v79, v132
    v_addc_co_u32 v131, s[56:57], 0, v131, s[50:51]
    v_cmp_gt_u32 s[48:49], v80, v132
    v_addc_co_u32 v131, s[56:57], 0, v131, s[52:53]
    v_cmp_gt_u32 s[50:51], v81, v132
    v_addc_co_u32 v131, s[56:57], 0, v131, s[54:55]
    v_cmp_gt_u32 s[52:53], v82, v132
    v_addc_co_u32 v131, s[56:57], 0, v131, s[48:49]
    v_cmp_gt_u32 s[54:55], v83, v132
    v_addc_co_u32 v131, s[56:57], 0, v131, s[50:51]
    v_cmp_gt_u32 s[48:49], v84, v132
    v_addc_co_u32 v131, s[56:57], 0, v131, s[52:53]
    v_cmp_gt_u32 s[50:51], v85, v132
    v_addc_co_u32 v131, s[56:57], 0, v131, s[54:55]
    v_cmp_gt_u32 s[52:53], v86, v132
    v_addc_co_u32 v131, s[56:57], 0, v131, s[48:49]
    v_cmp_gt_u32 s[54:55], v87, v132
    v_addc_co_u32 v131, s[56:57], 0, v131, s[50:51]
    v_addc_co_u32 v131, s[56:57], 0, v131, s[52:53]
    v_addc_co_u32 v131, s[56:57], 0, v131, s[54:55]
    v_mov_b32 v2, v131
    s_nop 1
    v_permlane32_swap_b32 v2, v131
    s_nop 1
    v_add_u32 v131, v2, v131
    v_mov_b32 v2, v131
    s_nop 1
    v_permlane16_swap_b32 v2, v131
    s_nop 1
    v_add_lshl_u32 v131, v2, v131, 2
    ds_write_b32 v131, v132 offset:8704
    s_add_u32 m0, s64, 36864
    s_add_u32 s40, s65, 1032192
    buffer_load_dwordx4 v226, s[72:75], s40 offen lds
    s_cmp_lg_u32 s26, 0
    s_waitcnt lgkmcnt(0)
    s_barrier
    s_cbranch_scc1 S_nc
    s_mov_b64 exec, 0xffff
    ds_read_b32 v132, v130 offset:8704
    s_waitcnt lgkmcnt(0)
    buffer_store_dwordx2 v[132:133], v14, s[16:19], s67 offen sc1
    s_mov_b64 exec, -1
S_nc:
    s_lshl_b32 s37, s95, 2
    s_add_u32 s37, s37, s26
    s_cmp_eq_u32 s37, 113
    s_cbranch_scc1 S_sel
S_seld:
    s_add_u32 m0, s64, 40960
    s_add_u32 s40, s65, 1146880
    buffer_load_dwordx4 v226, s[72:75], s40 offen lds
    s_add_u32 m0, s64, 45056
    s_add_u32 s40, s65, 1261568
    buffer_load_dwordx4 v226, s[72:75], s40 offen lds
    s_add_u32 m0, s64, 49152
    s_add_u32 s40, s65, 1376256
    buffer_load_dwordx4 v226, s[72:75], s40 offen lds
    s_add_u32 m0, s64, 53248
    s_add_u32 s40, s65, 1490944
    buffer_load_dwordx4 v226, s[72:75], s40 offen lds
    v_mov_b32 v8, 0
    v_mov_b32 v9, 0
    v_mov_b32 v10, 0
    v_mov_b32 v11, 0
    v_dot2c_f32_bf16 v8, v16, v100
    v_dot2c_f32_bf16 v9, v17, v101
    v_dot2c_f32_bf16 v10, v44, v100
    v_dot2c_f32_bf16 v11, v45, v101
    v_dot2c_f32_bf16 v8, v18, v102
    v_dot2c_f32_bf16 v9, v19, v103
    v_dot2c_f32_bf16 v10, v46, v102
    v_dot2c_f32_bf16 v11, v47, v103
    v_dot2c_f32_bf16 v8, v20, v104
    v_dot2c_f32_bf16 v9, v21, v105
    v_dot2c_f32_bf16 v10, v48, v104
    v_dot2c_f32_bf16 v11, v49, v105
    v_dot2c_f32_bf16 v8, v22, v106
    v_dot2c_f32_bf16 v9, v23, v107
    v_dot2c_f32_bf16 v10, v50, v106
    v_dot2c_f32_bf16 v11, v51, v107
    v_dot2c_f32_bf16 v8, v24, v108
    v_dot2c_f32_bf16 v9, v25, v109
    v_dot2c_f32_bf16 v10, v52, v108
    v_dot2c_f32_bf16 v11, v53, v109
    v_dot2c_f32_bf16 v8, v26, v110
    v_dot2c_f32_bf16 v9, v27, v111
    v_dot2c_f32_bf16 v10, v54, v110
    v_dot2c_f32_bf16 v11, v55, v111
    v_dot2c_f32_bf16 v8, v28, v112
    v_dot2c_f32_bf16 v9, v29, v113
    v_dot2c_f32_bf16 v10, v56, v112
    v_dot2c_f32_bf16 v11, v57, v113
    v_dot2c_f32_bf16 v8, v30, v114
    v_dot2c_f32_bf16 v9, v31, v115
    v_dot2c_f32_bf16 v10, v58, v114
    v_dot2c_f32_bf16 v11, v59, v115
    v_dot2c_f32_bf16 v8, v32, v116
    v_dot2c_f32_bf16 v9, v33, v117
    v_dot2c_f32_bf16 v10, v60, v116
    v_dot2c_f32_bf16 v11, v61, v117
    v_dot2c_f32_bf16 v8, v34, v118
    v_dot2c_f32_bf16 v9, v35, v119
    v_dot2c_f32_bf16 v10, v62, v118
    v_dot2c_f32_bf16 v11, v63, v119
    v_dot2c_f32_bf16 v8, v36, v120
    v_dot2c_f32_bf16 v9, v37, v121
    v_dot2c_f32_bf16 v10, v64, v120
    v_dot2c_f32_bf16 v11, v65, v121
    v_dot2c_f32_bf16 v8, v38, v122
    v_dot2c_f32_bf16 v9, v39, v123
    v_dot2c_f32_bf16 v10, v66, v122
    v_dot2c_f32_bf16 v11, v67, v123
    v_dot2c_f32_bf16 v8, v40, v124
    v_dot2c_f32_bf16 v9, v41, v125
    v_dot2c_f32_bf16 v10, v68, v124
    v_dot2c_f32_bf16 v11, v69, v125
    v_dot2c_f32_bf16 v8, v42, v126
    v_dot2c_f32_bf16 v9, v43, v127
    v_dot2c_f32_bf16 v10, v70, v126
    v_dot2c_f32_bf16 v11, v71, v127
    s_nop 2
    v_add_f32 v8, v8, v9
    v_add_f32 v10, v10, v11
    s_nop 0
    v_add_f32_dpp v8, v8, v8 quad_perm:[1,0,3,2] row_mask:0xf bank_mask:0xf
    v_add_f32_dpp v10, v10, v10 quad_perm:[1,0,3,2] row_mask:0xf bank_mask:0xf
    s_nop 0
    v_add_f32_dpp v8, v8, v8 quad_perm:[2,3,0,1] row_mask:0xf bank_mask:0xf
    v_add_f32_dpp v10, v10, v10 quad_perm:[2,3,0,1] row_mask:0xf bank_mask:0xf
    s_nop 0
    v_add_f32_dpp v8, v8, v8 row_half_mirror row_mask:0xf bank_mask:0xf
    v_add_f32_dpp v10, v10, v10 row_half_mirror row_mask:0xf bank_mask:0xf
    s_nop 0
    v_cndmask_b32 v8, v8, v10, s[58:59]
    v_lshlrev_b32 v2, 5, v13
    v_lshl_add_u32 v2, v12, 2, v2
    ds_bpermute_b32 v8, v2, v8
    v_mov_b32 v9, s68
    s_lshl_b32 s42, s60, 3
    s_add_u32 s42, s42, 16384
    v_mov_b32 v72, -1
    v_mov_b32 v73, -1
    v_mov_b32 v74, -1
    v_mov_b32 v75, -1
    s_lshl_b32 s39, s100, 7
    s_add_u32 s40, s39, 9437184
    s_add_u32 s39, s39, 65408
    v_mov_b32 v76, 0x7fffffff
    s_mov_b64 exec, 0xffff
    v_add_u32 v76, s39, v5
    s_mov_b64 exec, 0xff
    v_add_u32 v76, s40, v5
    s_mov_b64 exec, -1
    s_waitcnt lgkmcnt(0)
    s_mov_b64 exec, 0xffff
    buffer_store_dwordx2 v[8:9], v14, s[16:19], s42 offen sc1
    s_mov_b64 exec, -1
    buffer_store_dwordx4 v[72:75], v5, s[16:19], s101 offen sc1
    buffer_store_dwordx4 v[72:75], v5, s[16:19], s101 offen offset:1024 sc1
    buffer_store_dwordx4 v[72:75], v76, s[16:19], 0 offen sc1
    v_cmp_gt_u32 vcc, 16, v1
    v_lshrrev_b32 v2, 3, v1
    v_add_u32 v2, 1, v2
    v_bfe_u32 v3, v1, 1, 1
    v_cndmask_b32 v2, v3, v2, vcc
    v_bfe_u32 v3, v1, 2, 1
    v_and_b32 v4, 1, v1
    v_cndmask_b32 v3, v4, v3, vcc
    v_mul_u32_u24 v2, 448, v2
    v_mul_u32_u24 v3, 27, v3
    s_and_b32 s37, s100, 15
    s_mul_i32 s37, s37, 28
    v_add3_u32 v2, v2, v3, s37
    v_mul_u32_u24 v2, 683, v2
    v_lshrrev_b32 v2, 16, v2
    v_and_b32 v213, 3, v1
    s_lshl_b32 s37, s26, 2
    v_add_u32 v3, s37, v213
    s_lshr_b32 s37, s2, 4
    v_mov_b32 v4, s37
    v_cndmask_b32 v3, v4, v3, vcc
    v_lshl_add_u32 v2, v2, 4, v3
    v_lshlrev_b32 v238, 7, v2
    v_lshlrev_b32 v240, 4, v1
    s_add_u32 s39, s26, 1
    s_and_b32 s39, s39, 3
    s_mul_i32 s39, s39, 12288
    s_add_u32 s39, s39, 8192
    v_add_u32 v230, s39, v240
    s_add_u32 s39, s26, 2
    s_and_b32 s39, s39, 3
    s_mul_i32 s39, s39, 12288
    s_add_u32 s39, s39, 4096
    v_add_u32 v231, s39, v240
    s_add_u32 s39, s26, 3
    s_and_b32 s39, s39, 3
    s_mul_i32 s39, s39, 12288
    v_add_u32 v232, s39, v240
    s_add_u32 s39, s26, 4
    s_and_b32 s39, s39, 3
    s_mul_i32 s39, s39, 12288
    v_add_u32 v233, s39, v240
    v_add_u32 v241, 4096, v240
    v_add_u32 v242, 8192, v240
    v_add_u32 v243, 12288, v240
    v_mov_b32 v229, 0xdddddddd
    v_and_b32 v3, 0x33, v1
    v_bfe_u32 v2, v1, 2, 1
    v_lshl_or_b32 v3, v2, 3, v3
    v_bfe_u32 v2, v1, 3, 1
    v_lshl_or_b32 v3, v2, 2, v3
    v_lshlrev_b32 v234, 4, v3
    v_lshlrev_b32 v228, 7, v1
    v_lshrrev_b32 v212, 5, v1
    v_lshrrev_b32 v211, 2, v1
    v_sub_u32 v2, 1, v212
    v_cvt_f32_u32 v235, v2
    v_mul_u32_u24 v4, 3584, v211
    v_lshl_add_u32 v4, v213, 7, v4
    v_mov_b32 v227, 0x7fffffff
    v_mov_b32 v222, 0x7fffffff
    v_mov_b32 v223, 0x7fffffff
    s_mov_b64 exec, 4095
    v_mov_b32 v227, v228
    s_cmp_ge_u32 s29, 24
    s_cselect_b32 exec_lo, 4095, 0
    v_mov_b32 v227, v4
    s_mov_b64 exec, 0xff
    v_mov_b32 v223, v228
    s_mov_b64 exec, 1
    v_mov_b32 v222, 0
    s_mov_b64 exec, -1
    v_and_b32 v2, 7, v1
    v_lshlrev_b32 v225, 3, v2
    v_mov_b32 v220, s68
    v_mov_b32 v221, s69
    s_and_b32 s24, s100, 15
    s_lshr_b32 s25, s2, 4
    s_lshl_b32 s35, s24, 18
    s_add_u32 s35, s35, 3145728
    s_lshl_b32 s34, s26, 16
    s_add_u32 s34, s34, s35
    s_lshl_b32 s36, s24, 17
    s_lshl_b32 s37, s25, 13
    s_add_u32 s36, s36, s37
    s_add_u32 s36, s36, 1048576
    s_lshl_b32 s37, s26, 11
    s_add_u32 s47, s36, s37
    s_lshl_b32 s38, s29, 2
    s_add_u32 s38, s38, s26
    s_and_b32 s42, s2, 7
    s_mul_i32 s56, s38, 9216
    s_movk_i32 s57, 1536
    s_mov_b64 s[52:53], s[20:21]
    s_mov_b32 s54, 401408
    s_mov_b32 s55, 0x20000
    s_cmp_lt_u32 s38, 64
    s_cbranch_scc1 S_pf
    s_mul_i32 s39, s42, 229376
    s_add_u32 s56, s56, s39
    s_sub_u32 s56, s56, 589824
    s_mov_b64 s[52:53], s[98:99]
    s_cmp_lt_u32 s38, 89
    s_cselect_b32 s54, 1605632, 0
    s_cmp_lt_u32 s38, 96
    s_cbranch_scc1 S_pf
    s_sub_u32 s38, s38, 96
    s_mul_i32 s56, s38, 64512
    s_lshl_b32 s39, s42, 9
    s_add_u32 s56, s56, s39
    s_movk_i32 s57, 10752
    s_mov_b64 s[52:53], s[96:97]
    s_cmp_lt_u32 s42, 7
    s_cselect_b32 s54, 1605632, 0
S_pf:
    s_movk_i32 s63, 0x207
    s_mov_b32 s66, 0x61800000
    s_mov_b32 s67, s66
    s_lshl_b32 s60, s100, 7
    s_add_u32 s61, s60, 9437184
    s_add_u32 s60, s60, 65536
    s_and_b32 s27, s26, 1
    s_lshr_b32 s28, s26, 1
    s_lshl_b32 s30, s71, 1
    s_add_u32 s30, s30, s27
    s_lshl_b32 s59, s30, 1
    s_add_u32 s59, s59, s28
    s_lshl_b32 s36, s59, 14
    s_add_u32 s36, s36, 7340032
    s_lshl_b32 s59, s59, 10
    s_add_u32 s58, s59, 9437184
    s_sub_u32 s48, s64, 4096
    s_movk_i32 s49, 4096
    s_add_u32 s72, s65, 0
    s_add_u32 s73, s65, 114688
    s_add_u32 s74, s65, 229376
    s_add_u32 s75, s65, 344064
    s_add_u32 s76, s65, 458752
    s_add_u32 s77, s65, 573440
    s_add_u32 s78, s65, 688128
    s_add_u32 s79, s65, 802816
    s_add_u32 s80, s65, 917504
    s_add_u32 s81, s65, 1032192
    s_add_u32 s82, s65, 1146880
    s_add_u32 s83, s65, 1261568
    s_add_u32 s84, s65, 1376256
    s_add_u32 s85, s65, 1490944
    s_cmp_ge_u32 s95, 28
    s_cbranch_scc1 S_done
    v_lshrrev_b32 v8, 4, v1
    v_bfe_u32 v2, v1, 2, 2
    v_lshl_add_u32 v9, v8, 3, v2
    v_bfe_u32 v10, v1, 3, 2
    v_xor_b32 v3, s26, v10
    v_lshlrev_b32 v3, 5, v3
    v_lshl_add_u32 v3, v9, 7, v3
    v_lshl_add_u32 v3, v213, 3, v3
    v_add_u32 v180, 49152, v3
    v_mul_u32_u24 v9, 896, v9
    v_lshl_add_u32 v9, v213, 3, v9
    v_add_u32 v9, 106496, v9
    v_and_b32 v11, 15, v1
    v_mul_u32_u24 v2, 48, v11
    s_mul_i32 s37, s26, 12288
    v_lshl_add_u32 v3, v8, 3, v2
    v_add_u32 v181, s37, v3
    v_mul_u32_u24 v3, 12288, v212
    v_and_b32 v4, 1, v8
    v_lshl_add_u32 v3, v4, 4, v3
    v_add_u32 v182, v3, v2
    v_mul_u32_u24 v2, 464, v11
    v_lshl_add_u32 v2, v8, 4, v2
    s_add_u32 s41, s37, 1024
    v_add_u32 v206, s41, v2
    v_mul_u32_u24 v2, 912, v13
    v_lshl_add_u32 v12, v8, 4, v2
    s_mul_i32 s24, s95, 57344
    s_mul_i32 s37, s26, 14336
    s_add_u32 s24, s24, s37
    s_add_u32 s25, s37, 106496
    s_mul_i32 s38, s26, 7
    s_mul_i32 s27, s95, 1792
    s_mul_i32 s39, s26, 448
    s_add_u32 s27, s27, s39
    s_add_u32 s27, s27, 229376
    v_add_u32 v2, 0, v1
    v_mul_u32_u24 v3, 2341, v2
    v_lshrrev_b32 v3, 16, v3
    v_mul_u32_u24 v4, 28, v3
    v_sub_u32 v2, v2, v4
    v_mul_u32_u24 v4, 464, v3
    v_lshl_add_u32 v4, v2, 4, v4
    v_add_u32 v207, s41, v4
    v_mul_u32_u24 v4, 50176, v3
    v_lshl_add_u32 v183, v2, 4, v4
    v_add_u32 v2, 64, v1
    v_mul_u32_u24 v3, 2341, v2
    v_lshrrev_b32 v3, 16, v3
    v_mul_u32_u24 v4, 28, v3
    v_sub_u32 v2, v2, v4
    v_mul_u32_u24 v4, 464, v3
    v_lshl_add_u32 v4, v2, 4, v4
    v_add_u32 v208, s41, v4
    v_mul_u32_u24 v4, 50176, v3
    v_lshl_add_u32 v191, v2, 4, v4
    v_add_u32 v2, 128, v1
    v_mul_u32_u24 v3, 2341, v2
    v_lshrrev_b32 v3, 16, v3
    v_mul_u32_u24 v4, 28, v3
    v_sub_u32 v2, v2, v4
    v_mul_u32_u24 v4, 464, v3
    v_lshl_add_u32 v4, v2, 4, v4
    v_add_u32 v209, s41, v4
    v_mul_u32_u24 v4, 50176, v3
    v_lshl_add_u32 v224, v2, 4, v4
    v_add_u32 v2, 192, v1
    v_mul_u32_u24 v3, 2341, v2
    v_lshrrev_b32 v3, 16, v3
    v_mul_u32_u24 v4, 28, v3
    v_sub_u32 v2, v2, v4
    v_mul_u32_u24 v4, 464, v3
    v_lshl_add_u32 v4, v2, 4, v4
    v_add_u32 v210, s41, v4
    v_mul_u32_u24 v4, 50176, v3
    v_lshl_add_u32 v237, v2, 4, v4
    v_add_u32 v2, 0, v1
    v_mul_u32_u24 v3, 1171, v2
    v_bfe_u32 v3, v3, 17, 1
    v_lshlrev_b32 v3, 5, v3
    v_xor_b32 v192, v3, v240
    v_xor_b32 v199, 64, v192
    v_add_u32 v2, 64, v1
    v_mul_u32_u24 v3, 1171, v2
    v_bfe_u32 v3, v3, 17, 1
    v_lshlrev_b32 v3, 5, v3
    v_xor_b32 v193, v3, v240
    v_xor_b32 v200, 64, v193
    v_add_u32 v2, 128, v1
    v_mul_u32_u24 v3, 1171, v2
    v_bfe_u32 v3, v3, 17, 1
    v_lshlrev_b32 v3, 5, v3
    v_xor_b32 v194, v3, v240
    v_xor_b32 v201, 64, v194
    v_add_u32 v2, 192, v1
    v_mul_u32_u24 v3, 1171, v2
    v_bfe_u32 v3, v3, 17, 1
    v_lshlrev_b32 v3, 5, v3
    v_xor_b32 v195, v3, v240
    v_xor_b32 v202, 64, v195
    v_add_u32 v2, 256, v1
    v_mul_u32_u24 v3, 1171, v2
    v_bfe_u32 v3, v3, 17, 1
    v_lshlrev_b32 v3, 5, v3
    v_xor_b32 v196, v3, v240
    v_xor_b32 v203, 64, v196
    v_add_u32 v2, 320, v1
    v_mul_u32_u24 v3, 1171, v2
    v_bfe_u32 v3, v3, 17, 1
    v_lshlrev_b32 v3, 5, v3
    v_xor_b32 v197, v3, v240
    v_xor_b32 v204, 64, v197
    v_add_u32 v2, 384, v1
    v_mul_u32_u24 v3, 1171, v2
    v_bfe_u32 v3, v3, 17, 1
    v_lshlrev_b32 v3, 5, v3
    v_xor_b32 v198, v3, v240
    v_xor_b32 v205, 64, v198
    s_add_u32 s40, s38, 0
    v_xor_b32 v2, s40, v10
    v_lshl_add_u32 v184, v2, 5, v9
    s_add_u32 s40, s38, 1
    v_xor_b32 v2, s40, v10
    v_lshl_add_u32 v185, v2, 5, v9
    s_add_u32 s40, s38, 2
    v_xor_b32 v2, s40, v10
    v_lshl_add_u32 v186, v2, 5, v9
    s_add_u32 s40, s38, 3
    v_xor_b32 v2, s40, v10
    v_lshl_add_u32 v187, v2, 5, v9
    s_add_u32 s40, s38, 4
    v_xor_b32 v2, s40, v10
    v_lshl_add_u32 v188, v2, 5, v9
    s_add_u32 s40, s38, 5
    v_xor_b32 v2, s40, v10
    v_lshl_add_u32 v189, v2, 5, v9
    s_add_u32 s40, s38, 6
    v_xor_b32 v2, s40, v10
    v_lshl_add_u32 v190, v2, 5, v9
    s_mov_b32 exec_lo, 0
    v_mov_b32 v237, 0x7fffffff
    s_mov_b32 exec_lo, -1
    buffer_store_dwordx4 v[72:75], v183, s[16:19], s27 offen sc1
    buffer_store_dwordx4 v[72:75], v191, s[16:19], s27 offen sc1
    buffer_store_dwordx4 v[72:75], v224, s[16:19], s27 offen sc1
    buffer_store_dwordx4 v[72:75], v237, s[16:19], s27 offen sc1
    s_lshl_b32 s90, s26, 1
    s_add_u32 s41, s90, 1
    s_mul_i32 s42, s26, 1824
    s_add_u32 m0, s42, 12288
    s_mov_b32 s94, 131072
    s_mov_b64 exec, 0xff
S_sp:
    buffer_load_dwordx2 v[8:9], v225, s[16:19], 0 offen offset:256 sc1
    s_sub_u32 s94, s94, 1
    s_waitcnt vmcnt(0)
    v_cmp_ne_u32 vcc, s68, v9
    v_readlane_b32 s38, v8, s90
    v_readlane_b32 s39, v8, s41
    s_cmp_eq_u32 s94, 0
    s_cbranch_scc1 S_spd
    s_cmp_lg_u64 vcc, 0
    s_cbranch_scc1 S_sp
S_spd:
    s_mov_b32 exec_lo, -1
    s_mov_b32 exec_hi, 0xffffff
    s_and_b32 s38, s38, 0x7ff
    s_and_b32 s39, s39, 0x7ff
    s_sub_u32 s38, 2047, s38
    s_sub_u32 s39, 2047, s39
    s_mul_i32 s38, s38, 896
    s_mul_i32 s39, s39, 896
    buffer_load_dwordx4 v240, s[8:11], s38 offen lds
    s_add_u32 m0, s42, 13200
    s_nop 0
    buffer_load_dwordx4 v240, s[8:11], s39 offen lds
    s_mov_b64 exec, -1
    s_waitcnt vmcnt(0)
    s_barrier
    ds_read_b128 a[0:3], v12 offset:12288
    ds_read_b64_tr_b16 v[112:113], v180 offset:0
    ds_read_b64_tr_b16 v[114:115], v180 offset:512
    ds_read_b128 a[4:7], v12 offset:12352
    ds_read_b64_tr_b16 v[116:117], v180 offset:4096
    ds_read_b64_tr_b16 v[118:119], v180 offset:4608
    ds_read_b128 a[8:11], v12 offset:12416
    ds_read_b64_tr_b16 v[120:121], v180 offset:8192
    ds_read_b64_tr_b16 v[122:123], v180 offset:8704
    ds_read_b128 a[12:15], v12 offset:12480
    ds_read_b64_tr_b16 v[124:125], v180 offset:12288
    ds_read_b64_tr_b16 v[126:127], v180 offset:12800
    ds_read_b128 a[16:19], v12 offset:12544
    ds_read_b64_tr_b16 v[128:129], v180 offset:16384
    ds_read_b64_tr_b16 v[130:131], v180 offset:16896
    s_waitcnt lgkmcnt(12)
    v_mfma_f32_16x16x32_bf16 v[16:19], v[112:115], a[0:3], 0
    ds_read_b128 a[20:23], v12 offset:12608
    ds_read_b64_tr_b16 v[132:133], v180 offset:20480
    ds_read_b64_tr_b16 v[134:135], v180 offset:20992
    s_waitcnt lgkmcnt(12)
    v_mfma_f32_16x16x32_bf16 v[16:19], v[116:119], a[4:7], v[16:19]
    ds_read_b128 a[24:27], v12 offset:12672
    ds_read_b64_tr_b16 v[136:137], v180 offset:24576
    ds_read_b64_tr_b16 v[138:139], v180 offset:25088
    s_waitcnt lgkmcnt(12)
    v_mfma_f32_16x16x32_bf16 v[16:19], v[120:123], a[8:11], v[16:19]
    ds_read_b128 a[28:31], v12 offset:12736
    ds_read_b64_tr_b16 v[140:141], v180 offset:28672
    ds_read_b64_tr_b16 v[142:143], v180 offset:29184
    s_waitcnt lgkmcnt(12)
    v_mfma_f32_16x16x32_bf16 v[16:19], v[124:127], a[12:15], v[16:19]
    ds_read_b128 a[32:35], v12 offset:12800
    ds_read_b64_tr_b16 v[144:145], v180 offset:32768
    ds_read_b64_tr_b16 v[146:147], v180 offset:33280
    s_waitcnt lgkmcnt(12)
    v_mfma_f32_16x16x32_bf16 v[16:19], v[128:131], a[16:19], v[16:19]
    ds_read_b128 a[36:39], v12 offset:12864
    ds_read_b64_tr_b16 v[148:149], v180 offset:36864
    ds_read_b64_tr_b16 v[150:151], v180 offset:37376
    s_waitcnt lgkmcnt(12)
    v_mfma_f32_16x16x32_bf16 v[16:19], v[132:135], a[20:23], v[16:19]
    ds_read_b128 a[40:43], v12 offset:12928
    ds_read_b64_tr_b16 v[152:153], v180 offset:40960
    ds_read_b64_tr_b16 v[154:155], v180 offset:41472
    s_waitcnt lgkmcnt(12)
    v_mfma_f32_16x16x32_bf16 v[16:19], v[136:139], a[24:27], v[16:19]
    s_mov_b32 s37, 32768
    s_mov_b64 exec, 0x3ffff
    buffer_load_dwordx2 v[6:7], v238, s[16:19], s37 offen sc1
    s_mov_b64 exec, -1
    ds_read_b128 a[44:47], v12 offset:12992
    ds_read_b64_tr_b16 v[156:157], v180 offset:45056
    ds_read_b64_tr_b16 v[158:159], v180 offset:45568
    s_waitcnt lgkmcnt(12)
    v_mfma_f32_16x16x32_bf16 v[16:19], v[140:143], a[28:31], v[16:19]
    ds_read_b128 a[48:51], v12 offset:13056
    ds_read_b64_tr_b16 v[160:161], v180 offset:49152
    ds_read_b64_tr_b16 v[162:163], v180 offset:49664
    s_waitcnt lgkmcnt(12)
    v_mfma_f32_16x16x32_bf16 v[16:19], v[144:147], a[32:35], v[16:19]
    ds_read_b128 a[52:55], v12 offset:13120
    ds_read_b64_tr_b16 v[164:165], v180 offset:53248
    ds_read_b64_tr_b16 v[166:167], v180 offset:53760
    s_waitcnt lgkmcnt(12)
    v_mfma_f32_16x16x32_bf16 v[16:19], v[148:151], a[36:39], v[16:19]
    s_waitcnt lgkmcnt(9)
    v_mfma_f32_16x16x32_bf16 v[16:19], v[152:155], a[40:43], v[16:19]
    s_waitcnt lgkmcnt(6)
    v_mfma_f32_16x16x32_bf16 v[16:19], v[156:159], a[44:47], v[16:19]
    s_waitcnt lgkmcnt(3)
    v_mfma_f32_16x16x32_bf16 v[16:19], v[160:163], a[48:51], v[16:19]
    s_waitcnt lgkmcnt(0)
    v_mfma_f32_16x16x32_bf16 v[16:19], v[164:167], a[52:55], v[16:19]
    s_nop 7
    v_cvt_pk_bf16_f32 v16, v16, v17
    v_cvt_pk_bf16_f32 v18, v18, v19
    v_and_b32 v17, 0xffff0000, v16
    v_lshlrev_b32 v16, 16, v16
    v_and_b32 v19, 0xffff0000, v18
    v_lshlrev_b32 v18, 16, v18
    v_mul_f32 v20, 0xbfb8aa3b, v16
    v_mul_f32 v21, 0xbfb8aa3b, v17
    v_mul_f32 v22, 0xbfb8aa3b, v18
    v_mul_f32 v23, 0xbfb8aa3b, v19
    v_exp_f32 v20, v20
    v_exp_f32 v21, v21
    v_exp_f32 v22, v22
    v_exp_f32 v23, v23
    v_add_f32 v20, 1.0, v20
    v_add_f32 v21, 1.0, v21
    v_add_f32 v22, 1.0, v22
    v_add_f32 v23, 1.0, v23
    v_rcp_f32 v20, v20
    v_rcp_f32 v21, v21
    v_rcp_f32 v22, v22
    v_rcp_f32 v23, v23
    v_pk_mul_f32 v[176:177], v[16:17], v[20:21]
    v_pk_mul_f32 v[178:179], v[18:19], v[22:23]
    s_barrier
    s_mov_b32 s94, 131072
    s_mov_b64 exec, 0x3ffff
    s_branch P2_chk
S_done:
    s_barrier
    s_branch P2_start
S_sel:
    v_mov_b32 v220, s68
    v_lshrrev_b32 v6, 1, v1
    v_lshlrev_b32 v6, 7, v6
    v_and_b32 v2, 1, v1
    v_lshl_add_u32 v6, v2, 5, v6
    v_mov_b32 v131, 0
    s_movk_i32 s37, 4096
    s_mov_b32 s94, 131072
S_poll:
    buffer_load_dwordx4 v[168:171], v6, s[16:19], s37 offen sc1
    buffer_load_dwordx4 v[172:175], v6, s[16:19], s37 offen offset:16 sc1
    s_sub_u32 s94, s94, 1
    s_waitcnt vmcnt(0)
    v_xor_b32 v2, v220, v169
    v_bitop3_b32 v2, v2, v220, v171 bitop3:0xf6
    v_bitop3_b32 v2, v2, v220, v173 bitop3:0xf6
    v_bitop3_b32 v2, v2, v220, v175 bitop3:0xf6
    v_cmp_ne_u32 vcc, 0, v2
    v_mov_b32 v15, v168
    s_cmp_eq_u32 s94, 0
    s_cbranch_scc1 S_polld
    s_cmp_lg_u64 vcc, 0
    s_cbranch_scc1 S_poll
S_polld:
    v_mov_b32 v9, s68
    v_mov_b32 v8, 0
    v_max_u32_dpp v15, v15, v15 row_shr:1 row_mask:0xf bank_mask:0xf
    s_nop 1
    v_max_u32_dpp v15, v15, v15 row_shr:2 row_mask:0xf bank_mask:0xf
    s_nop 1
    v_max_u32_dpp v15, v15, v15 row_shr:4 row_mask:0xf bank_mask:0xf
    s_nop 1
    v_max_u32_dpp v15, v15, v15 row_shr:8 row_mask:0xf bank_mask:0xf
    s_nop 1
    v_max_u32_dpp v15, v15, v15 row_bcast:15 row_mask:0xa bank_mask:0xf
    s_nop 1
    v_max_u32_dpp v15, v15, v15 row_bcast:31 row_mask:0xc bank_mask:0xf
    s_nop 0
    v_readlane_b32 s38, v15, 63
    s_nop 1
    v_cmp_eq_u32 vcc, s38, v168
    v_writelane_b32 v8, s38, 0
    s_nop 0
    v_cndmask_b32 v15, v168, v170, vcc
    v_cndmask_b32 v168, v168, v170, vcc
    v_cndmask_b32 v170, v170, v172, vcc
    v_cndmask_b32 v172, v172, v174, vcc
    v_cndmask_b32 v174, v174, v131, vcc
    v_max_u32_dpp v15, v15, v15 row_shr:1 row_mask:0xf bank_mask:0xf
    s_nop 1
    v_max_u32_dpp v15, v15, v15 row_shr:2 row_mask:0xf bank_mask:0xf
    s_nop 1
    v_max_u32_dpp v15, v15, v15 row_shr:4 row_mask:0xf bank_mask:0xf
    s_nop 1
    v_max_u32_dpp v15, v15, v15 row_shr:8 row_mask:0xf bank_mask:0xf
    s_nop 1
    v_max_u32_dpp v15, v15, v15 row_bcast:15 row_mask:0xa bank_mask:0xf
    s_nop 1
    v_max_u32_dpp v15, v15, v15 row_bcast:31 row_mask:0xc bank_mask:0xf
    s_nop 0
    v_readlane_b32 s38, v15, 63
    s_nop 1
    v_cmp_eq_u32 vcc, s38, v168
    v_writelane_b32 v8, s38, 1
    s_nop 0
    v_cndmask_b32 v15, v168, v170, vcc
    v_cndmask_b32 v168, v168, v170, vcc
    v_cndmask_b32 v170, v170, v172, vcc
    v_cndmask_b32 v172, v172, v174, vcc
    v_cndmask_b32 v174, v174, v131, vcc
    v_max_u32_dpp v15, v15, v15 row_shr:1 row_mask:0xf bank_mask:0xf
    s_nop 1
    v_max_u32_dpp v15, v15, v15 row_shr:2 row_mask:0xf bank_mask:0xf
    s_nop 1
    v_max_u32_dpp v15, v15, v15 row_shr:4 row_mask:0xf bank_mask:0xf
    s_nop 1
    v_max_u32_dpp v15, v15, v15 row_shr:8 row_mask:0xf bank_mask:0xf
    s_nop 1
    v_max_u32_dpp v15, v15, v15 row_bcast:15 row_mask:0xa bank_mask:0xf
    s_nop 1
    v_max_u32_dpp v15, v15, v15 row_bcast:31 row_mask:0xc bank_mask:0xf
    s_nop 0
    v_readlane_b32 s38, v15, 63
    s_nop 1
    v_cmp_eq_u32 vcc, s38, v168
    v_writelane_b32 v8, s38, 2
    s_nop 0
    v_cndmask_b32 v15, v168, v170, vcc
    v_cndmask_b32 v168, v168, v170, vcc
    v_cndmask_b32 v170, v170, v172, vcc
    v_cndmask_b32 v172, v172, v174, vcc
    v_cndmask_b32 v174, v174, v131, vcc
    v_max_u32_dpp v15, v15, v15 row_shr:1 row_mask:0xf bank_mask:0xf
    s_nop 1
    v_max_u32_dpp v15, v15, v15 row_shr:2 row_mask:0xf bank_mask:0xf
    s_nop 1
    v_max_u32_dpp v15, v15, v15 row_shr:4 row_mask:0xf bank_mask:0xf
    s_nop 1
    v_max_u32_dpp v15, v15, v15 row_shr:8 row_mask:0xf bank_mask:0xf
    s_nop 1
    v_max_u32_dpp v15, v15, v15 row_bcast:15 row_mask:0xa bank_mask:0xf
    s_nop 1
    v_max_u32_dpp v15, v15, v15 row_bcast:31 row_mask:0xc bank_mask:0xf
    s_nop 0
    v_readlane_b32 s38, v15, 63
    s_nop 1
    v_cmp_eq_u32 vcc, s38, v168
    v_writelane_b32 v8, s38, 3
    s_nop 0
    v_cndmask_b32 v15, v168, v170, vcc
    v_cndmask_b32 v168, v168, v170, vcc
    v_cndmask_b32 v170, v170, v172, vcc
    v_cndmask_b32 v172, v172, v174, vcc
    v_cndmask_b32 v174, v174, v131, vcc
    v_max_u32_dpp v15, v15, v15 row_shr:1 row_mask:0xf bank_mask:0xf
    s_nop 1
    v_max_u32_dpp v15, v15, v15 row_shr:2 row_mask:0xf bank_mask:0xf
    s_nop 1
    v_max_u32_dpp v15, v15, v15 row_shr:4 row_mask:0xf bank_mask:0xf
    s_nop 1
    v_max_u32_dpp v15, v15, v15 row_shr:8 row_mask:0xf bank_mask:0xf
    s_nop 1
    v_max_u32_dpp v15, v15, v15 row_bcast:15 row_mask:0xa bank_mask:0xf
    s_nop 1
    v_max_u32_dpp v15, v15, v15 row_bcast:31 row_mask:0xc bank_mask:0xf
    s_nop 0
    v_readlane_b32 s38, v15, 63
    s_nop 1
    v_cmp_eq_u32 vcc, s38, v168
    v_writelane_b32 v8, s38, 4
    s_nop 0
    v_cndmask_b32 v15, v168, v170, vcc
    v_cndmask_b32 v168, v168, v170, vcc
    v_cndmask_b32 v170, v170, v172, vcc
    v_cndmask_b32 v172, v172, v174, vcc
    v_cndmask_b32 v174, v174, v131, vcc
    v_max_u32_dpp v15, v15, v15 row_shr:1 row_mask:0xf bank_mask:0xf
    s_nop 1
    v_max_u32_dpp v15, v15, v15 row_shr:2 row_mask:0xf bank_mask:0xf
    s_nop 1
    v_max_u32_dpp v15, v15, v15 row_shr:4 row_mask:0xf bank_mask:0xf
    s_nop 1
    v_max_u32_dpp v15, v15, v15 row_shr:8 row_mask:0xf bank_mask:0xf
    s_nop 1
    v_max_u32_dpp v15, v15, v15 row_bcast:15 row_mask:0xa bank_mask:0xf
    s_nop 1
    v_max_u32_dpp v15, v15, v15 row_bcast:31 row_mask:0xc bank_mask:0xf
    s_nop 0
    v_readlane_b32 s38, v15, 63
    s_nop 1
    v_cmp_eq_u32 vcc, s38, v168
    v_writelane_b32 v8, s38, 5
    s_nop 0
    v_cndmask_b32 v15, v168, v170, vcc
    v_cndmask_b32 v168, v168, v170, vcc
    v_cndmask_b32 v170, v170, v172, vcc
    v_cndmask_b32 v172, v172, v174, vcc
    v_cndmask_b32 v174, v174, v131, vcc
    v_max_u32_dpp v15, v15, v15 row_shr:1 row_mask:0xf bank_mask:0xf
    s_nop 1
    v_max_u32_dpp v15, v15, v15 row_shr:2 row_mask:0xf bank_mask:0xf
    s_nop 1
    v_max_u32_dpp v15, v15, v15 row_shr:4 row_mask:0xf bank_mask:0xf
    s_nop 1
    v_max_u32_dpp v15, v15, v15 row_shr:8 row_mask:0xf bank_mask:0xf
    s_nop 1
    v_max_u32_dpp v15, v15, v15 row_bcast:15 row_mask:0xa bank_mask:0xf
    s_nop 1
    v_max_u32_dpp v15, v15, v15 row_bcast:31 row_mask:0xc bank_mask:0xf
    s_nop 0
    v_readlane_b32 s38, v15, 63
    s_nop 1
    v_cmp_eq_u32 vcc, s38, v168
    v_writelane_b32 v8, s38, 6
    s_nop 0
    v_cndmask_b32 v15, v168, v170, vcc
    v_cndmask_b32 v168, v168, v170, vcc
    v_cndmask_b32 v170, v170, v172, vcc
    v_cndmask_b32 v172, v172, v174, vcc
    v_cndmask_b32 v174, v174, v131, vcc
    v_max_u32_dpp v15, v15, v15 row_shr:1 row_mask:0xf bank_mask:0xf
    s_nop 1
    v_max_u32_dpp v15, v15, v15 row_shr:2 row_mask:0xf bank_mask:0xf
    s_nop 1
    v_max_u32_dpp v15, v15, v15 row_shr:4 row_mask:0xf bank_mask:0xf
    s_nop 1
    v_max_u32_dpp v15, v15, v15 row_shr:8 row_mask:0xf bank_mask:0xf
    s_nop 1
    v_max_u32_dpp v15, v15, v15 row_bcast:15 row_mask:0xa bank_mask:0xf
    s_nop 1
    v_max_u32_dpp v15, v15, v15 row_bcast:31 row_mask:0xc bank_mask:0xf
    s_nop 0
    v_readlane_b32 s38, v15, 63
    s_nop 1
    v_writelane_b32 v8, s38, 7
    s_mov_b64 exec, 0xffff
    buffer_store_dwordx2 v[8:9], v14, s[16:19], 0 offen offset:256 sc1
    s_mov_b64 exec, -1
    s_branch S_seld
TEXT_END:
P2_fallback:
    s_mov_b32 exec_lo, 0
    v_mov_b32 v46, 0
    s_mov_b32 exec_lo, -1
    s_mov_b32 s34, s35
    s_mov_b32 s40, 64
    v_mov_b32 v12, 0xff800000
P2_fb1:
    buffer_load_dwordx4 a[128:131], v240, s[16:19], s34 offen offset:0 sc1
    buffer_load_dwordx4 a[132:135], v240, s[16:19], s34 offen offset:1024 sc1
    s_waitcnt vmcnt(0)
    v_mfma_f32_32x32x16_bf16 v[112:127], a[128:131], v[40:43], 0
    v_mfma_f32_32x32x16_bf16 v[112:127], a[132:135], v[44:47], v[112:127]
    s_nop 15
    v_max3_f32 v12, v12, v112, v113
    v_max3_f32 v12, v12, v114, v115
    v_max3_f32 v12, v12, v116, v117
    v_max3_f32 v12, v12, v118, v119
    v_max3_f32 v12, v12, v120, v121
    v_max3_f32 v12, v12, v122, v123
    v_max3_f32 v12, v12, v124, v125
    v_max3_f32 v12, v12, v126, v127
    s_add_u32 s34, s34, 4096
    s_sub_u32 s40, s40, 1
    s_cmp_lg_u32 s40, 0
    s_cbranch_scc1 P2_fb1
    v_mov_b32 v13, v12
    s_nop 1
    v_permlane32_swap_b32 v12, v13
    s_nop 1
    v_max_f32 v12, v12, v13
    s_mov_b32 s34, s35
    s_mov_b32 s40, 64
    v_mov_b32 v48, 0
    v_mov_b32 v49, 0
    v_mov_b32 v50, 0
    v_mov_b32 v51, 0
    v_mov_b32 v52, 0
    v_mov_b32 v53, 0
    v_mov_b32 v54, 0
    v_mov_b32 v55, 0
    v_mov_b32 v56, 0
    v_mov_b32 v57, 0
    v_mov_b32 v58, 0
    v_mov_b32 v59, 0
    v_mov_b32 v60, 0
    v_mov_b32 v61, 0
    v_mov_b32 v62, 0
    v_mov_b32 v63, 0
P2_fb2:
    buffer_load_dwordx4 a[128:131], v240, s[16:19], s34 offen offset:0 sc1
    buffer_load_dwordx4 a[132:135], v240, s[16:19], s34 offen offset:1024 sc1
    buffer_load_dwordx4 a[136:139], v240, s[16:19], s34 offen offset:2048 sc1
    buffer_load_dwordx4 a[140:143], v240, s[16:19], s34 offen offset:3072 sc1
    s_waitcnt vmcnt(0)
    v_mfma_f32_32x32x16_bf16 v[112:127], a[128:131], v[40:43], 0
    v_mfma_f32_32x32x16_bf16 v[112:127], a[132:135], v[44:47], v[112:127]
    s_nop 15
    v_sub_f32 v112, v112, v12
    v_sub_f32 v113, v113, v12
    v_sub_f32 v114, v114, v12
    v_sub_f32 v115, v115, v12
    v_sub_f32 v116, v116, v12
    v_sub_f32 v117, v117, v12
    v_sub_f32 v118, v118, v12
    v_sub_f32 v119, v119, v12
    v_sub_f32 v120, v120, v12
    v_sub_f32 v121, v121, v12
    v_sub_f32 v122, v122, v12
    v_sub_f32 v123, v123, v12
    v_sub_f32 v124, v124, v12
    v_sub_f32 v125, v125, v12
    v_sub_f32 v126, v126, v12
    v_sub_f32 v127, v127, v12
    v_exp_f32 v112, v112
    v_exp_f32 v113, v113
    v_exp_f32 v114, v114
    v_exp_f32 v115, v115
    v_exp_f32 v116, v116
    v_exp_f32 v117, v117
    v_exp_f32 v118, v118
    v_exp_f32 v119, v119
    v_exp_f32 v120, v120
    v_exp_f32 v121, v121
    v_exp_f32 v122, v122
    v_exp_f32 v123, v123
    v_exp_f32 v124, v124
    v_exp_f32 v125, v125
    v_exp_f32 v126, v126
    v_exp_f32 v127, v127
    s_nop 1
    v_smfmac_f32_32x32x32_bf16 v[48:63], a[136:139], v[112:119], v229
    v_smfmac_f32_32x32x32_bf16 v[48:63], a[140:143], v[120:127], v229
    s_add_u32 s34, s34, 4096
    s_sub_u32 s40, s40, 1
    s_cmp_lg_u32 s40, 0
    s_cbranch_scc1 P2_fb2
    s_nop 15
    v_mov_b32 v8, v60
    v_mov_b32 v11, v60
    s_nop 1
    v_permlane32_swap_b32 v8, v11
    s_nop 1
    v_rcp_f32 v10, v11
    s_mov_b64 vcc, 0
    s_branch P2_finish
P3_ymore:
    s_ff1_i32_b32 s48, s44
    s_mul_i32 s47, s48, 50176
    s_add_u32 s79, s47, s45
    s_add_u32 s80, s79, 7168
    s_add_u32 s81, s79, 14336
    s_add_u32 s82, s79, 21504
    s_add_u32 s83, s79, 28672
    s_add_u32 s84, s79, 35840
    s_add_u32 s85, s79, 43008
    buffer_load_dwordx2 v[160:161], v10, s[16:19], s79 offen sc1
    buffer_load_dwordx2 v[162:163], v10, s[16:19], s80 offen sc1
    buffer_load_dwordx2 v[164:165], v10, s[16:19], s81 offen sc1
    buffer_load_dwordx2 v[166:167], v10, s[16:19], s82 offen sc1
    buffer_load_dwordx2 v[168:169], v10, s[16:19], s83 offen sc1
    buffer_load_dwordx2 v[170:171], v10, s[16:19], s84 offen sc1
    buffer_load_dwordx2 v[172:173], v10, s[16:19], s85 offen sc1
    s_branch P3_yz1
P3_fpwait:
    s_movk_i32 s37, 64
    s_mov_b32 s94, 131072
P3_fpoll:
    buffer_load_dwordx2 v[218:219], v244, s[16:19], s37 offen sc1
    s_sub_u32 s94, s94, 1
    s_waitcnt vmcnt(0)
    v_cmp_ne_u64 vcc, s[68:69], v[218:219]
    s_cmp_eq_u32 s94, 0
    s_cbranch_scc1 P3_fpoll_d
    s_cmp_lg_u64 vcc, 0
    s_cbranch_scc1 P3_fpoll
P3_fpoll_d:
    s_mov_b64 exec, -1
P3_selre:
    buffer_load_dwordx2 v[214:215], v225, s[16:19], 0 offen offset:256 sc1
    buffer_load_dwordx2 v[8:9], v237, s[16:19], s91 offen sc1
    buffer_load_dwordx2 v[10:11], v237, s[16:19], s91 offen offset:128 sc1
    s_sub_u32 s94, s94, 1
    s_waitcnt vmcnt(0)
    v_xor_b32 v2, s68, v9
    v_xor_b32 v3, s68, v11
    v_xor_b32 v4, s68, v215
    v_or3_b32 v2, v2, v3, v4
    v_cmp_ne_u32 vcc, 0, v2
    s_cmp_le_i32 s94, 0
    s_cbranch_scc1 P3_selok
    s_cmp_lg_u64 vcc, 0
    s_cbranch_scc1 P3_selre
P3_selok:
    v_cvt_pk_bf16_f32 v200, v8, v10
    v_and_b32 v201, 0xffff0000, v200
    v_lshlrev_b32 v200, 16, v200
    v_mul_f32 v200, 0xbfb8aa3b, v200
    v_mul_f32 v201, 0xbfb8aa3b, v201
    v_exp_f32 v200, v200
    v_exp_f32 v201, v201
    s_nop 0
    v_add_f32 v200, 1.0, v200
    v_add_f32 v201, 1.0, v201
    v_rcp_f32 v200, v200
    v_rcp_f32 v201, v201
    s_nop 0
    v_cvt_pk_bf16_f32 v200, v200, v201
    v_and_b32 v201, 0xffff0000, v200
    v_lshlrev_b32 v200, 16, v200
    v_sub_f32 v202, 1.0, v200
    v_sub_f32 v203, 1.0, v201
    v_lshlrev_b32 v184, 16, v176
    v_and_b32 v185, 0xffff0000, v176
    v_pk_mul_f32 v[184:185], v[184:185], v[202:203] op_sel_hi:[1,0]
    v_lshlrev_b32 v186, 16, v177
    v_and_b32 v187, 0xffff0000, v177
    v_pk_mul_f32 v[186:187], v[186:187], v[202:203] op_sel_hi:[1,0]
    v_lshlrev_b32 v188, 16, v178
    v_and_b32 v189, 0xffff0000, v178
    v_pk_mul_f32 v[188:189], v[188:189], v[202:203] op_sel_hi:[1,0]
    v_lshlrev_b32 v190, 16, v179
    v_and_b32 v191, 0xffff0000, v179
    v_pk_mul_f32 v[190:191], v[190:191], v[202:203] op_sel_hi:[1,0]
    v_lshlrev_b32 v192, 16, v180
    v_and_b32 v193, 0xffff0000, v180
    v_pk_mul_f32 v[192:193], v[192:193], v[202:203] op_sel:[0,1] op_sel_hi:[1,1]
    v_lshlrev_b32 v194, 16, v181
    v_and_b32 v195, 0xffff0000, v181
    v_pk_mul_f32 v[194:195], v[194:195], v[202:203] op_sel:[0,1] op_sel_hi:[1,1]
    v_lshlrev_b32 v196, 16, v182
    v_and_b32 v197, 0xffff0000, v182
    v_pk_mul_f32 v[196:197], v[196:197], v[202:203] op_sel:[0,1] op_sel_hi:[1,1]
    v_lshlrev_b32 v198, 16, v183
    v_and_b32 v199, 0xffff0000, v183
    v_pk_mul_f32 v[198:199], v[198:199], v[202:203] op_sel:[0,1] op_sel_hi:[1,1]
    s_mov_b32 s94, 131072
    s_branch P3_fpok
.section .rodata,"a"
.p2align 6
.amdhsa_kernel gated_mix__softmax_full_mha__moe_arch_mod__prompt_kernel
  .amdhsa_next_free_vgpr 448
  .amdhsa_next_free_sgpr 102
  .amdhsa_accum_offset 256
  .amdhsa_group_segment_fixed_size 0
  .amdhsa_kernarg_size 96
  .amdhsa_user_sgpr_count 2
  .amdhsa_user_sgpr_kernarg_segment_ptr 1
  .amdhsa_system_sgpr_workgroup_id_x 1
.end_amdhsa_kernel
```
